```python
import torch

def _softmax(x, axis=-1):
    return torch.softmax(x, dim=axis)
def _gelu(x):
    return torch.nn.functional.gelu(x, approximate="tanh")
def _silu(x):
    return torch.nn.functional.silu(x)
def _sigmoid(x):
    return torch.sigmoid(x)
def _layernorm(x, axis=-1, eps=1e-5):
    m = x.mean(dim=axis, keepdim=True)
    v = x.var(dim=axis, keepdim=True, unbiased=False)
    return (x - m) / torch.sqrt(v + eps)
def _scatter_add(tgt, idx, src, axis=0):
    return tgt.clone().index_add_(axis, idx, src)
def _segment_sum(src, seg, n):
    out = torch.zeros((n,) + src.shape[1:], dtype=src.dtype)
    return out.index_add_(0, seg, src)
def _pad(x, pw):
    flat = tuple(v for pair in reversed(pw) for v in pair)
    return torch.nn.functional.pad(x, flat)

kernel_name = 'gated_mix__sliding_block__sliding_local_dilated__prompt'

def setup_inputs():

    _w = (lambda a: (lambda t: t.to(torch.bfloat16) if t.is_floating_point() else t)(torch.as_tensor(a)))
    def _A_setup():
        B, S, D = 1, 2048, 448
        return {
            "x": _w((lambda *s: torch.randn(*s, dtype=torch.bfloat16) * 0.05)(B, S, D)),
            "wqkv": _w((lambda *s: torch.randn(*s, dtype=torch.bfloat16) * 1.6)(D, 3 * D)),
            "wo": _w((lambda *s: torch.randn(*s, dtype=torch.bfloat16) * 0.05)(D, D)),
        }
    _A_in = _A_setup()

    def _B_setup():
        B, S, D = 1, 2048, 448
        return {
            "x": _w((lambda *s: torch.randn(*s, dtype=torch.bfloat16) * 0.05)(B, S, D)),
            "wqkv": _w((lambda *s: torch.randn(*s, dtype=torch.bfloat16) * 1.6)(D, 3 * D)),
            "wo": _w((lambda *s: torch.randn(*s, dtype=torch.bfloat16) * 0.05)(D, D)),
        }
    _B_in = _B_setup()

    return {
        "A_x": _A_in["x"],
        "A_wqkv": _A_in["wqkv"],
        "A_wo": _A_in["wo"],
        "B_x": _B_in["x"],
        "B_wqkv": _B_in["wqkv"],
        "B_wo": _B_in["wo"],
        "gate_w": _w((lambda *s: torch.randn(*s, dtype=torch.bfloat16) * 0.05)(448) * 16.0),
    }

def reference(A_x, A_wqkv, A_wo, B_x, B_wqkv, B_wo, gate_w):
    def _A_ref(x, wqkv, wo):
        B, S, D = x.shape
        H = 16; Dh = D // H; W = 256
        qkv = (lambda x, *d: x.permute(*d))((x @ wqkv).reshape(B, S, 3, H, Dh), 2, 0, 3, 1, 4)
        q, k, v = qkv[0], qkv[1], qkv[2]
        scores = torch.einsum("bhqd,bhkd->bhqk", q, k) * (Dh ** -0.5)
        idx = torch.arange(S)
        mask = (idx[:, None] - idx[None, :] >= 0) & (idx[:, None] - idx[None, :] < W)
        scores = torch.where(mask[None, None], scores, -1e9)
        p = _softmax(scores, axis=-1)
        o = torch.einsum("bhqk,bhkd->bhqd", p, v)
        return (lambda x, *d: x.permute(*d))(o, 0, 2, 1, 3).reshape(B, S, D) @ wo

    def _B_ref(x, wqkv, wo):
        B, S, D = x.shape
        H = 16; Dh = D // H
        W, dil = 8, 2
        qkv = (lambda x, *d: x.permute(*d))((x @ wqkv).reshape(B, S, 3, H, Dh), 2, 0, 3, 1, 4)
        q, k, v = qkv[0], qkv[1], qkv[2]
        scale = Dh ** -0.5
        pos = torch.arange(S)
        off = torch.arange(W) * dil
        idx = pos[:, None] - off[None, :]
        mask = idx >= 0
        idx_c = torch.where(mask, idx, 0).reshape(-1)
        kg = k[:, :, idx_c, :].reshape(B, H, S, W, Dh)
        vg = v[:, :, idx_c, :].reshape(B, H, S, W, Dh)
        logits = torch.einsum("bhsd,bhswd->bhsw", q, kg) * scale
        logits = torch.where(mask[None, None, :, :], logits, -1e9)
        attn = _softmax(logits, axis=-1)
        o = torch.einsum("bhsw,bhswd->bhsd", attn, vg)
        return (lambda x, *d: x.permute(*d))(o, 0, 2, 1, 3).reshape(B, S, D) @ wo

    x = A_x
    g = _sigmoid((x * gate_w).sum(-1, keepdims=True))
    a = _A_ref(x, A_wqkv, A_wo)
    b = _B_ref(x, B_wqkv, B_wo)
    return g * a + (1 - g) * b
```

```asm
; @launch grid=(256,1,1) block=(512,1,1) lds=163840
.amdgcn_target "amdgcn-amd-amdhsa--gfx950"
.text
.globl gated_mix__sliding_block__sliding_local_dilated__prompt_kernel
.p2align 8
.type gated_mix__sliding_block__sliding_local_dilated__prompt_kernel,@function
gated_mix__sliding_block__sliding_local_dilated__prompt_kernel:
K_START:
    s_cmp_ge_u32 s2, 256
    s_cbranch_scc1 K_END
    s_load_dwordx16 s[64:79], s[0:1], 0
    s_load_dwordx4 s[80:83], s[0:1], 64
    v_and_b32 v1, 63, v0
    v_lshrrev_b32 v2, 6, v0
    s_and_b32 s57, s2, 7
    v_readfirstlane_b32 s56, v2
    s_lshr_b32 s58, s2, 3
    s_and_b32 s59, s56, 3
    s_lshr_b32 s55, s56, 2
    s_cmp_lt_u32 s56, 4
    s_cbranch_scc1 COMPUTE

    s_lshr_b32 s19, s58, 4
    s_lshr_b32 s17, s57, 2
    s_lshl_b32 s17, s17, 3
    s_bfe_u32 s25, s58, 0x30001
    s_add_u32 s17, s17, s25
    s_and_b32 s18, s57, 3
    s_lshl_b32 s18, s18, 1
    s_and_b32 s24, s58, 1
    s_add_u32 s18, s18, s24
    s_lshl_b32 s20, s24, 1
    s_add_u32 s20, s20, s25
    s_lshl_b32 s23, s19, 2
    s_add_u32 s20, s20, s23
    s_cmp_ge_u32 s20, 7
    s_cselect_b32 s25, 7, 0
    s_sub_u32 s20, s20, s25

    v_lshrrev_b32 v6, 3, v1
    v_and_b32 v7, 7, v1
    v_lshrrev_b32 v8, 4, v1
    v_mul_u32_u24 v6, 896, v6
    v_xor_b32 v7, v7, v8
    s_lshl_b32 s23, s17, 2
    v_lshlrev_b32 v7, 4, v7
    s_add_u32 s23, s23, s59
    v_add_u32 v3, v6, v7
    s_mul_i32 s29, s23, 28672
    v_xor_b32 v7, 64, v7
    s_lshl_b32 s28, s59, 12
    v_add_u32 v4, v6, v7
    s_lshl_b32 s23, s19, 11
    s_add_u32 s28, s28, s23
    s_add_u32 s28, s28, 21552
    s_lshl_b32 s31, s20, 7
    s_cmp_eq_u32 s19, 0
    s_mov_b32 s32, 39984
    s_cselect_b32 s32, 37936, s32
    s_add_u32 s26, s31, s29
    s_add_u32 s34, s28, s32
    s_mov_b32 s6, 1835008
    s_mov_b32 s7, 0x20000
    s_waitcnt lgkmcnt(0)
    s_mov_b32 s4, s64
    s_mov_b32 s5, s65

    s_add_u32 m0, s34, 0
    s_add_u32 s24, s26, 0
    buffer_load_dwordx4 v3, s[4:7], s24 offen lds
    s_add_u32 m0, s34, 1024
    s_add_u32 s24, s26, 7168
    buffer_load_dwordx4 v4, s[4:7], s24 offen lds
    s_add_u32 m0, s34, 2048
    s_add_u32 s24, s26, 14336
    buffer_load_dwordx4 v3, s[4:7], s24 offen lds
    s_add_u32 m0, s34, 3072
    s_add_u32 s24, s26, 21504
    buffer_load_dwordx4 v4, s[4:7], s24 offen lds
    v_mul_u32_u24 v6, 37, v1
    s_lshr_b32 s23, s59, 1
    v_lshrrev_b32 v6, 8, v6
    s_lshl_b32 s23, s23, 5
    v_mul_u32_u24 v7, 7, v6
    s_and_b32 s24, s59, 1
    v_sub_u32 v7, v1, v7
    s_lshl_b32 s24, s24, 2
    v_and_b32 v8, 1, v6
    s_add_u32 s23, s23, s24
    v_lshlrev_b32 v8, 4, v8
    s_mul_i32 s21, s23, 2688
    v_lshrrev_b32 v6, 1, v6
    s_mul_i32 s27, s59, 1792
    v_add_u32 v8, v8, v6
    s_cmp_eq_u32 s19, 0
    v_mul_u32_u24 v8, 2688, v8
    s_mov_b32 s24, 896
    v_lshl_add_u32 v2, v7, 4, v8
    s_cselect_b32 s22, 112, s24
    s_mov_b32 s24, 112
    s_cselect_b32 s23, 336, s24
    s_cselect_b32 s8, s66, s72
    s_cselect_b32 s9, s67, s73
    s_add_u32 s34, s27, s32
    s_mul_i32 s23, s18, s23
    s_mov_b32 s10, 1204224
    s_add_u32 s21, s21, s23
    s_mov_b32 s11, 0x20000
    s_mul_i32 s30, s20, 172032
    s_mov_b32 exec_hi, 0x00ffffff
    s_add_u32 s30, s30, s21

    s_add_u32 m0, s34, 0
    s_mov_b32 s24, s30
    buffer_load_dwordx4 v2, s[8:11], s24 offen lds
    s_add_u32 m0, s34, 7184
    s_add_u32 s24, s24, s22
    buffer_load_dwordx4 v2, s[8:11], s24 offen lds
    s_add_u32 m0, s34, 14368
    s_add_u32 s24, s24, s22
    buffer_load_dwordx4 v2, s[8:11], s24 offen lds
    s_add_u32 m0, s34, 896
    s_add_u32 s24, s30, 21504
    buffer_load_dwordx4 v2, s[8:11], s24 offen lds
    s_add_u32 m0, s34, 8080
    s_add_u32 s24, s24, s22
    buffer_load_dwordx4 v2, s[8:11], s24 offen lds
    s_add_u32 m0, s34, 15264
    s_add_u32 s24, s24, s22
    buffer_load_dwordx4 v2, s[8:11], s24 offen lds
    s_mov_b32 exec_hi, -1
    s_lshl_b32 s23, s17, 7
    s_sub_u32 s23, s23, 16
    s_and_b32 s24, s59, 1
    s_lshl_b32 s25, s24, 3
    s_add_u32 s23, s23, s25
    s_mul_i32 s23, s23, 896
    s_cmp_eq_u32 s24, 0
    s_cselect_b64 vcc, -1, 0
    v_cndmask_b32 v5, v4, v3, vcc
    v_add_u32 v5, s23, v5
    s_lshl_b32 s36, s24, 10
    s_add_u32 s36, s36, 21552
    s_lshr_b32 s23, s59, 1
    s_xor_b32 s24, s19, 1
    s_or_b32 s37, s23, s24
    s_cmp_lg_u32 s37, 0
    s_cselect_b64 vcc, -1, 0
    v_mov_b32 v6, 2147483648
    v_cndmask_b32 v5, v5, v6, vcc
    s_lshl_b32 s38, s32, 2
    s_add_u32 s25, s38, 1024
    s_add_u32 s24, s36, s32
    s_cmp_lg_u32 s37, 0
    s_cselect_b32 m0, s25, s24
    s_add_u32 s20, s20, 1
    buffer_load_dwordx4 v5, s[4:7], s31 offen lds
    s_cmp_eq_u32 s20, 7
    s_cselect_b32 s20, 0, s20
    s_lshl_b32 s33, s32, 1
    s_mov_b32 s35, 1

    s_mov_b32 s40, s76
    s_mov_b32 s41, s77
    s_mov_b32 s42, 896
    s_mov_b32 s43, 0x20000
    v_lshlrev_b32 v6, 4, v1
    s_mov_b32 m0, s38
    s_nop 0
    buffer_load_dwordx4 v6, s[40:43], 0 offen lds

    s_lshr_b32 s54, s58, 4
    s_lshl_b32 s23, s57, 1
    s_add_u32 s54, s54, s23
    s_and_b32 s39, s58, 15
    s_mul_i32 s23, s54, 131072
    s_add_u32 s12, s82, s23
    s_addc_u32 s13, s83, 0
    s_mov_b32 s14, 131072
    s_mov_b32 s15, 0x20000

    s_mul_i32 s23, s58, 37
    s_lshr_b32 s23, s23, 8
    s_mul_i32 s24, s23, 7
    s_sub_u32 s101, s58, s24
    s_lshl_b32 s100, s57, 2
    s_add_u32 s100, s100, s23

    s_lshl_b32 s23, s59, 10
    s_lshl_b32 s52, s100, 12
    s_add_u32 s52, s52, s23

    s_add_u32 s92, s82, 6291456
    s_addc_u32 s93, s83, 0
    s_mov_b32 s94, 4194304
    s_mov_b32 s95, 0x20000
    s_mov_b32 s96, s68
    s_mov_b32 s97, s69
    s_mov_b32 s98, 401408
    s_mov_b32 s99, 0x20000
    v_lshrrev_b32 v6, 3, v1
    v_lshrrev_b32 v7, 2, v6
    v_lshlrev_b32 v7, 3, v7
    v_and_b32 v8, 3, v6
    v_add_u32 v7, v7, v8
    v_mul_u32_u24 v235, 896, v7
    v_bfe_u32 v7, v1, 4, 2
    v_bfe_u32 v8, v1, 1, 2
    v_xor_b32 v7, v7, v8
    v_lshlrev_b32 v7, 5, v7
    v_and_b32 v8, 1, v1
    v_lshlrev_b32 v8, 4, v8
    v_add3_u32 v235, v235, v7, v8
    s_and_b32 s23, s59, 1
    s_lshl_b32 s23, s23, 4
    s_lshr_b32 s24, s59, 1
    s_lshl_b32 s24, s24, 2
    s_add_u32 s23, s23, s24
    s_mul_i32 s23, s23, 896
    s_lshl_b32 s24, s101, 7
    s_add_u32 s23, s23, s24
    v_add_u32 v235, s23, v235

    v_mov_b32 v7, 2147483648
    v_cmp_lt_u32 vcc, 31, v1
    s_cmp_eq_u32 s59, 3
    s_cselect_b64 vcc, vcc, 0
    s_nop 1
    v_cndmask_b32 v236, v235, v7, vcc

    v_lshrrev_b32 v7, 4, v1
    v_lshrrev_b32 v8, 1, v7
    v_lshlrev_b32 v8, 3, v8
    v_and_b32 v9, 1, v7
    v_lshl_add_u32 v8, v9, 2, v8
    v_bfe_u32 v9, v1, 2, 2
    v_add_u32 v8, v8, v9
    v_bfe_u32 v9, v8, 1, 2
    v_lshlrev_b32 v8, 7, v8
    v_and_b32 v6, 3, v1
    v_lshl_add_u32 v8, v6, 3, v8
    v_add_u32 v8, 77824, v8

    v_xor_b32 v6, 0, v9
    v_lshl_add_u32 v229, v6, 5, v8
    v_xor_b32 v6, 1, v9
    v_lshl_add_u32 v230, v6, 5, v8
    v_xor_b32 v6, 2, v9
    v_lshl_add_u32 v231, v6, 5, v8
    v_xor_b32 v6, 3, v9
    v_lshl_add_u32 v232, v6, 5, v8
    v_and_b32 v6, 15, v1
    v_lshrrev_b32 v7, 2, v6
    v_and_b32 v8, 1, v7
    v_lshlrev_b32 v8, 1, v8
    v_lshrrev_b32 v9, 1, v7
    v_mul_u32_u24 v9, 3, v9
    v_xor_b32 v8, v8, v9

    v_lshrrev_b32 v7, 4, v1
    v_xor_b32 v8, v8, v7
    v_lshlrev_b32 v8, 4, v8
    v_lshl_add_u32 v228, v6, 6, v8

    v_lshlrev_b32 v234, 4, v1
    s_lshl_b32 s23, s59, 10
    v_add_u32 v228, s23, v228
    s_lshl_b32 s23, s100, 6
    s_lshl_b32 s24, s59, 4
    s_add_u32 s23, s23, s24
    v_add_u32 v8, s23, v6
    v_lshlrev_b32 v8, 3, v8
    v_add_u32 v233, 10485760, v8
    s_lshl_b32 s24, s59, 12
    s_add_u32 s60, s24, 0
    s_cmp_lt_u32 s59, 2
    s_mov_b32 s61, 144896
    s_cselect_b32 s61, 114688, s61
    s_add_u32 s61, s61, s24
    v_lshrrev_b32 v8, 4, v1
    v_xor_b32 v8, v8, v6
    v_lshlrev_b32 v8, 4, v8
    v_lshl_add_u32 v8, v6, 8, v8
    v_add_u32 v241, s61, v8
    v_lshrrev_b32 v8, 3, v1
    v_add_u32 v8, 8, v8
    v_and_b32 v9, 7, v1
    v_lshlrev_b32 v7, 1, v9
    v_xor_b32 v7, v7, v8
    v_lshlrev_b32 v7, 4, v7
    v_lshl_add_u32 v7, v8, 8, v7
    v_add_u32 v239, s60, v7
    v_add_u32 v240, s61, v7
    v_add_u32 v8, s23, v8
    v_mul_u32_u24 v8, 896, v8
    v_lshl_add_u32 v238, v9, 4, v8

    s_mov_b32 s88, s78
    s_mov_b32 s89, s79
    s_mov_b32 s90, 1835008
    s_mov_b32 s91, 0x20000
    v_mov_b32 v237, 0
    s_mov_b32 s44, s74
    s_mov_b32 s45, s75
    s_mov_b32 s46, 401408
    s_mov_b32 s47, 0x20000
    s_mov_b32 s40, s82
    s_mov_b32 s41, s83
    s_mov_b32 s42, 10633216
    s_mov_b32 s43, 0x20000
    v_min_u32 v6, 6, v1
    v_add_u32 v7, 2, v6
    v_mul_u32_u24 v8, 86, v7
    v_lshrrev_b32 v8, 8, v8
    v_mul_u32_u24 v9, 3, v8
    v_sub_u32 v7, v7, v9
    v_add_u32 v7, s39, v7
    v_subrev_u32 v7, 2, v7
    v_max_i32 v7, 0, v7
    v_lshlrev_b32 v7, 13, v7
    v_lshlrev_b32 v8, 4, v8
    v_add_u32 v8, s54, v8
    v_mul_u32_u24 v8, 512, v8
    v_lshl_add_u32 v7, v8, 8, v7
    v_add_u32 v17, 8172, v7

    s_lshl_b32 s23, s39, 13
    s_sub_u32 s23, s23, 16384
    s_lshl_b32 s53, s59, 10
    s_add_u32 s23, s23, s53
    v_lshlrev_b32 v13, 4, v1
    v_add_u32 v11, s23, v13
    v_and_b32 v6, 15, v1
    v_lshrrev_b32 v7, 2, v6

    v_and_b32 v8, 1, v7
    v_lshlrev_b32 v8, 1, v8
    v_lshrrev_b32 v9, 1, v7
    v_mul_u32_u24 v9, 3, v9
    v_xor_b32 v8, v8, v9

    v_xor_b32 v8, 3, v8
    v_lshlrev_b32 v8, 4, v8
    v_lshl_add_u32 v14, v6, 6, v8
    v_add_u32 v14, 12, v14
    v_lshrrev_b32 v7, 4, v1
    s_lshl_b32 s23, s39, 1
    s_sub_i32 s23, 4, s23
    v_mov_b32 v9, -1

    v_add_u32 v6, 0, v7
    v_cmp_le_i32 vcc, s23, v6
    s_nop 1
    v_cndmask_b32 v15, 0, v9, vcc

    v_add_u32 v6, 4, v7
    v_cmp_le_i32 vcc, s23, v6
    s_nop 1
    v_cndmask_b32 v16, 0, v9, vcc

    v_lshl_add_u32 v18, v7, 12, v14
    v_add_u32 v18, s53, v18
    v_lshrrev_b32 v7, 4, v1
    v_and_b32 v6, 1, v7
    v_lshl_add_u32 v19, v6, 10, v14
    s_lshl_b32 s23, s59, 11
    s_add_u32 s23, s23, 115712
    v_add_u32 v19, s23, v19
    s_lshl_b32 s23, s59, 2
    s_add_u32 s23, s23, 163712
    v_mov_b32 v20, s23
    s_mul_i32 s23, s58, 14
    s_and_b32 s24, s59, 1
    s_mul_i32 s24, s24, 7
    s_add_u32 s23, s23, s24
    v_mul_u32_u24 v6, 37, v1
    v_lshrrev_b32 v6, 8, v6
    v_mul_u32_u24 v7, 7, v6
    v_sub_u32 v7, v1, v7
    v_add_u32 v6, s23, v6
    v_mul_u32_u24 v6, 896, v6
    v_lshl_add_u32 v21, v7, 7, v6

L_main_1:
    s_mul_i32 s30, s20, 172032
    s_add_u32 s30, s30, s21
    s_lshl_b32 s31, s20, 7
    s_add_u32 s26, s31, s29
    s_add_u32 s34, s33, s28

    s_add_u32 m0, s34, 0
    s_add_u32 s24, s26, 0
    buffer_load_dwordx4 v3, s[4:7], s24 offen lds
    s_add_u32 m0, s34, 1024
    s_add_u32 s24, s26, 7168
    buffer_load_dwordx4 v4, s[4:7], s24 offen lds
    s_add_u32 m0, s34, 2048
    s_add_u32 s24, s26, 14336
    buffer_load_dwordx4 v3, s[4:7], s24 offen lds
    s_add_u32 m0, s34, 3072
    s_add_u32 s24, s26, 21504
    buffer_load_dwordx4 v4, s[4:7], s24 offen lds
    s_add_u32 s34, s33, s27
    s_mov_b32 exec_hi, 0x00ffffff
    s_add_u32 m0, s34, 0
    s_mov_b32 s24, s30
    buffer_load_dwordx4 v2, s[8:11], s24 offen lds
    s_add_u32 m0, s34, 7184
    s_add_u32 s24, s24, s22
    buffer_load_dwordx4 v2, s[8:11], s24 offen lds
    s_add_u32 m0, s34, 14368
    s_add_u32 s24, s24, s22
    buffer_load_dwordx4 v2, s[8:11], s24 offen lds
    s_add_u32 m0, s34, 896
    s_add_u32 s24, s30, 21504
    buffer_load_dwordx4 v2, s[8:11], s24 offen lds
    s_add_u32 m0, s34, 8080
    s_add_u32 s24, s24, s22
    buffer_load_dwordx4 v2, s[8:11], s24 offen lds
    s_add_u32 m0, s34, 15264
    s_add_u32 s24, s24, s22
    buffer_load_dwordx4 v2, s[8:11], s24 offen lds
    s_mov_b32 exec_hi, -1
    s_add_u32 s24, s33, s36
    s_add_u32 s25, s38, 1024
    s_cmp_lg_u32 s37, 0
    s_cselect_b32 m0, s25, s24
    s_add_u32 s20, s20, 1

    buffer_load_dwordx4 v5, s[4:7], s31 offen lds
    s_cmp_eq_u32 s20, 7
    s_cselect_b32 s20, 0, s20
    s_add_u32 s33, s33, s32
    s_cmp_eq_u32 s33, s38
    s_cselect_b32 s33, 0, s33
    s_add_u32 s35, s35, 1

    s_waitcnt vmcnt(11)
    s_barrier
    s_cmp_lt_u32 s35, 7
    s_cbranch_scc1 L_main_1
    v_mov_b32 v10, 0
    global_load_dword v10, v10, s[80:81] sc1
    s_waitcnt vmcnt(1)
    s_barrier
    s_waitcnt vmcnt(0)
    v_readfirstlane_b32 s3, v10
    s_cmp_lg_u32 s3, 0
    s_cbranch_scc1 tag_2_done
    s_mov_b32 s62, 0
tag_2:
    v_mov_b32 v10, 0
    global_load_dword v10, v10, s[80:81] sc1
    s_waitcnt vmcnt(0)
    v_readfirstlane_b32 s3, v10
    s_add_u32 s62, s62, 1
    s_cmp_gt_u32 s62, 65536
    s_cbranch_scc1 tag_2_done
    s_cmp_eq_u32 s3, 0
    s_cbranch_scc1 tag_2

tag_2_done:
    s_lshr_b32 s23, s59, 1
    s_cmp_eq_u32 s23, 0
    s_cselect_b32 s4, s68, s74
    s_cselect_b32 s5, s69, s75
    s_mov_b32 s6, 401408
    s_mov_b32 s7, 0x20000

    s_mov_b32 exec_hi, 0x1ffff
    buffer_load_dword v255, v21, s[4:7], 0 offen
    s_mov_b32 exec_hi, -1

    v_and_b32 v15, s3, v15
    v_and_b32 v16, s3, v16
    s_mul_i32 s23, s54, 131072

    s_add_u32 s24, s23, 2097152
    s_add_u32 s4, s82, s24
    s_addc_u32 s5, s83, 0
    s_mov_b32 s6, 131072
    s_mov_b32 s7, 0x20000
    s_add_u32 s24, s23, 4194304
    s_add_u32 s8, s82, s24
    s_addc_u32 s9, s83, 0
    s_mov_b32 s10, 131072
    s_mov_b32 s11, 0x20000
    s_cmp_eq_u32 s19, 0
    s_cbranch_scc1 nobg_3
    s_barrier
nobg_3:
    v_lshlrev_b32 v6, 2, v1
    v_add_u32 v6, 163712, v6
    v_mov_b32 v7, 0
    s_mov_b64 exec, 0xffff
    ds_write_b32 v6, v7
    s_mov_b64 exec, -1
    s_waitcnt lgkmcnt(0)
    s_barrier

    s_cmp_eq_u32 s19, 1
    s_cbranch_scc1 L_roleB_4
    s_cmp_lt_u32 s18, 6
    s_cbranch_scc1 vfirst_5
    s_cmp_ge_u32 s58, 28
    s_cbranch_scc1 vfirst_5
    s_cmp_eq_u32 s56, 4
    s_cbranch_scc1 vfirst_5
    s_cmp_eq_u32 s59, 3
    s_cselect_b32 exec_hi, 0, -1
    s_add_u32 m0, s53, 59904
    s_mov_b32 s23, 75264
    buffer_load_dwordx4 v235, s[44:47], s23 offen lds
    s_add_u32 m0, s53, 63488
    s_mov_b32 s23, 100352
    buffer_load_dwordx4 v235, s[44:47], s23 offen lds
    s_add_u32 m0, s53, 67072
    s_mov_b32 s23, 125440
    buffer_load_dwordx4 v235, s[44:47], s23 offen lds
    s_add_u32 m0, s53, 70656
    s_mov_b32 s23, 150528
    buffer_load_dwordx4 v235, s[44:47], s23 offen lds
    s_add_u32 m0, s53, 74240
    s_mov_b32 s23, 175616
    buffer_load_dwordx4 v235, s[44:47], s23 offen lds
    s_add_u32 m0, s53, 77824
    s_mov_b32 s23, 200704
    buffer_load_dwordx4 v235, s[44:47], s23 offen lds
    s_add_u32 m0, s53, 81408
    s_mov_b32 s23, 225792
    buffer_load_dwordx4 v235, s[44:47], s23 offen lds
    s_add_u32 m0, s53, 84992
    s_mov_b32 s23, 250880
    buffer_load_dwordx4 v235, s[44:47], s23 offen lds
    s_add_u32 m0, s53, 88576
    s_mov_b32 s23, 275968
    buffer_load_dwordx4 v235, s[44:47], s23 offen lds
    s_add_u32 m0, s53, 92160
    s_mov_b32 s23, 301056
    buffer_load_dwordx4 v235, s[44:47], s23 offen lds
    s_add_u32 m0, s53, 95744
    s_mov_b32 s23, 326144
    buffer_load_dwordx4 v235, s[44:47], s23 offen lds
    s_add_u32 m0, s53, 99328
    s_mov_b32 s23, 351232
    buffer_load_dwordx4 v235, s[44:47], s23 offen lds
    s_mov_b32 exec_hi, -1
    s_add_u32 m0, s53, 102912
    s_mov_b32 s23, 376320
    buffer_load_dwordx4 v236, s[44:47], s23 offen lds
    v_lshlrev_b32 v6, 4, v1
    s_lshl_b32 s23, s56, 10
    v_add_u32 v6, s23, v6
    s_mul_i32 s24, s18, 786432
    s_lshl_b32 s25, s17, 13
    s_add_u32 s24, s24, s25

    ds_read_b128 v[32:35], v6 offset:0
    ds_read_b128 v[36:39], v6 offset:8192
    ds_read_b128 v[40:43], v6 offset:16384
    ds_read_b128 v[44:47], v6 offset:24576
    ds_read_b128 v[48:51], v6 offset:32768
    ds_read_b128 v[52:55], v6 offset:40960
    s_waitcnt lgkmcnt(5)
    s_add_u32 s25, s24, 0
    buffer_store_dwordx4 v[32:35], v6, s[40:43], s25 offen sc1
    s_waitcnt lgkmcnt(4)
    s_add_u32 s25, s24, 131072
    buffer_store_dwordx4 v[36:39], v6, s[40:43], s25 offen sc1
    s_waitcnt lgkmcnt(3)
    s_add_u32 s25, s24, 262144
    buffer_store_dwordx4 v[40:43], v6, s[40:43], s25 offen sc1
    s_waitcnt lgkmcnt(2)
    s_add_u32 s25, s24, 393216
    buffer_store_dwordx4 v[44:47], v6, s[40:43], s25 offen sc1
    s_waitcnt lgkmcnt(1)
    s_add_u32 s25, s24, 524288
    buffer_store_dwordx4 v[48:51], v6, s[40:43], s25 offen sc1
    s_waitcnt lgkmcnt(0)
    s_add_u32 s25, s24, 655360
    buffer_store_dwordx4 v[52:55], v6, s[40:43], s25 offen sc1
    s_branch vfirst_5_j_done
vfirst_5:
    v_lshlrev_b32 v6, 4, v1
    s_lshl_b32 s23, s56, 10
    v_add_u32 v6, s23, v6
    s_mul_i32 s24, s18, 786432
    s_lshl_b32 s25, s17, 13
    s_add_u32 s24, s24, s25

    ds_read_b128 v[32:35], v6 offset:0
    ds_read_b128 v[36:39], v6 offset:8192
    ds_read_b128 v[40:43], v6 offset:16384
    ds_read_b128 v[44:47], v6 offset:24576
    ds_read_b128 v[48:51], v6 offset:32768
    ds_read_b128 v[52:55], v6 offset:40960
    s_waitcnt lgkmcnt(5)
    s_add_u32 s25, s24, 0
    buffer_store_dwordx4 v[32:35], v6, s[40:43], s25 offen sc1
    s_waitcnt lgkmcnt(4)
    s_add_u32 s25, s24, 131072
    buffer_store_dwordx4 v[36:39], v6, s[40:43], s25 offen sc1
    s_waitcnt lgkmcnt(3)
    s_add_u32 s25, s24, 262144
    buffer_store_dwordx4 v[40:43], v6, s[40:43], s25 offen sc1
    s_waitcnt lgkmcnt(2)
    s_add_u32 s25, s24, 393216
    buffer_store_dwordx4 v[44:47], v6, s[40:43], s25 offen sc1
    s_waitcnt lgkmcnt(1)
    s_add_u32 s25, s24, 524288
    buffer_store_dwordx4 v[48:51], v6, s[40:43], s25 offen sc1
    s_waitcnt lgkmcnt(0)
    s_add_u32 s25, s24, 655360
    buffer_store_dwordx4 v[52:55], v6, s[40:43], s25 offen sc1
    s_cmp_ge_u32 s58, 28
    s_cbranch_scc1 ewob_6
    s_cmp_eq_u32 s56, 4
    s_cbranch_scc1 ewob_6
    s_cmp_eq_u32 s59, 3
    s_cselect_b32 exec_hi, 0, -1
    s_add_u32 m0, s53, 59904
    s_mov_b32 s23, 75264
    buffer_load_dwordx4 v235, s[44:47], s23 offen lds
    s_add_u32 m0, s53, 63488
    s_mov_b32 s23, 100352
    buffer_load_dwordx4 v235, s[44:47], s23 offen lds
    s_add_u32 m0, s53, 67072
    s_mov_b32 s23, 125440
    buffer_load_dwordx4 v235, s[44:47], s23 offen lds
    s_add_u32 m0, s53, 70656
    s_mov_b32 s23, 150528
    buffer_load_dwordx4 v235, s[44:47], s23 offen lds
    s_add_u32 m0, s53, 74240
    s_mov_b32 s23, 175616
    buffer_load_dwordx4 v235, s[44:47], s23 offen lds
    s_add_u32 m0, s53, 77824
    s_mov_b32 s23, 200704
    buffer_load_dwordx4 v235, s[44:47], s23 offen lds
    s_add_u32 m0, s53, 81408
    s_mov_b32 s23, 225792
    buffer_load_dwordx4 v235, s[44:47], s23 offen lds
    s_add_u32 m0, s53, 84992
    s_mov_b32 s23, 250880
    buffer_load_dwordx4 v235, s[44:47], s23 offen lds
    s_add_u32 m0, s53, 88576
    s_mov_b32 s23, 275968
    buffer_load_dwordx4 v235, s[44:47], s23 offen lds
    s_add_u32 m0, s53, 92160
    s_mov_b32 s23, 301056
    buffer_load_dwordx4 v235, s[44:47], s23 offen lds
    s_add_u32 m0, s53, 95744
    s_mov_b32 s23, 326144
    buffer_load_dwordx4 v235, s[44:47], s23 offen lds
    s_add_u32 m0, s53, 99328
    s_mov_b32 s23, 351232
    buffer_load_dwordx4 v235, s[44:47], s23 offen lds
    s_mov_b32 exec_hi, -1
    s_add_u32 m0, s53, 102912
    s_mov_b32 s23, 376320
    buffer_load_dwordx4 v236, s[44:47], s23 offen lds
ewob_6:
vfirst_5_j_done:
    s_cmp_lg_u32 s56, 4
    s_cbranch_scc1 noprobe_7
    s_mov_b64 exec, 0xf
    s_mov_b32 s62, 0
poll_8:
    global_load_dword v6, v17, s[82:83] sc1
    s_add_u32 s62, s62, 1
    s_waitcnt vmcnt(0)
    v_cmp_ne_u32 vcc, s3, v6
    s_cmp_gt_u32 s62, 65536
    s_cbranch_scc1 poll_8_done
    s_cbranch_vccz poll_8_done
    s_sleep 3
    s_branch poll_8

poll_8_done:
    s_mov_b64 exec, -1
noprobe_7:
    s_waitcnt lgkmcnt(0)
    s_barrier
    s_mov_b32 s62, 0
kq_retry_9:
    v_add_u32 v6, 20480, v11
    s_add_u32 m0, s53, 20480
    s_nop 0
    buffer_load_dwordx4 v6, s[4:7], 0 offen sc1 lds
    v_subrev_u32 v6, 4096, v6
    s_add_u32 m0, s53, 16384
    s_nop 0
    buffer_load_dwordx4 v6, s[4:7], 0 offen sc1 lds
    v_subrev_u32 v6, 4096, v6
    s_add_u32 m0, s53, 12288
    s_nop 0
    buffer_load_dwordx4 v6, s[4:7], 0 offen sc1 lds
    v_subrev_u32 v6, 4096, v6
    s_add_u32 m0, s53, 8192
    s_nop 0
    buffer_load_dwordx4 v6, s[4:7], 0 offen sc1 lds
    v_subrev_u32 v6, 4096, v6
    s_add_u32 m0, s53, 4096
    s_nop 0
    buffer_load_dwordx4 v6, s[4:7], 0 offen sc1 lds
    v_subrev_u32 v6, 4096, v6
    s_add_u32 m0, s53, 0
    s_nop 0
    buffer_load_dwordx4 v6, s[4:7], 0 offen sc1 lds
    s_lshl_b32 s23, s39, 13
    s_lshl_b32 s24, s59, 11
    s_add_u32 s23, s23, s24
    s_add_u32 m0, s24, 115712
    s_add_u32 s25, s23, 1024
    buffer_load_dwordx4 v13, s[12:15], s23 offen sc1 lds
    s_add_u32 m0, s24, 116736
    s_nop 0
    buffer_load_dwordx4 v13, s[12:15], s25 offen sc1 lds

    s_waitcnt vmcnt(0)
    ds_read_b32 v24, v19
    s_waitcnt lgkmcnt(0)
    v_cmp_ne_u32 vcc, s3, v24

    ds_read_b32 v22, v18 offset:0
    ds_read_b32 v23, v18 offset:16384
    s_waitcnt lgkmcnt(0)
    v_cmp_ne_u32 s[84:85], v22, v15
    v_cmp_ne_u32 s[86:87], v23, v16
    s_nop 1
    s_mov_b32 s87, 0
    s_or_b64 vcc, vcc, s[84:85]
    s_or_b64 vcc, vcc, s[86:87]

    s_add_u32 s62, s62, 1
    s_cmp_gt_u32 s62, 65536
    s_cbranch_scc1 kq_retry_9_done
    s_cbranch_vccnz kq_retry_9
kq_retry_9_done:
    v_add_u32 v6, 20480, v11
    s_add_u32 m0, s53, 45056
    s_nop 0
    buffer_load_dwordx4 v6, s[8:11], 0 offen sc1 lds
    v_subrev_u32 v6, 4096, v6
    s_add_u32 m0, s53, 40960
    s_nop 0
    buffer_load_dwordx4 v6, s[8:11], 0 offen sc1 lds
    v_subrev_u32 v6, 4096, v6
    s_add_u32 m0, s53, 36864
    s_nop 0
    buffer_load_dwordx4 v6, s[8:11], 0 offen sc1 lds
    v_subrev_u32 v6, 4096, v6
    s_add_u32 m0, s53, 32768
    s_nop 0
    buffer_load_dwordx4 v6, s[8:11], 0 offen sc1 lds
    v_subrev_u32 v6, 4096, v6
    s_add_u32 m0, s53, 28672
    s_nop 0
    buffer_load_dwordx4 v6, s[8:11], 0 offen sc1 lds
    v_subrev_u32 v6, 4096, v6
    s_add_u32 m0, s53, 24576
    s_nop 0
    buffer_load_dwordx4 v6, s[8:11], 0 offen sc1 lds
    s_branch L_roleB_4_j
L_roleB_4:
    s_cmp_lg_u32 s56, 4
    s_cbranch_scc1 B_other_11
    s_mov_b64 exec, 0xf
    s_mov_b32 s62, 0
poll_12:
    global_load_dword v6, v17, s[82:83] sc1
    s_add_u32 s62, s62, 1
    s_waitcnt vmcnt(0)
    v_cmp_ne_u32 vcc, s3, v6
    s_cmp_gt_u32 s62, 65536
    s_cbranch_scc1 poll_12_done
    s_cbranch_vccz poll_12_done
    s_sleep 3
    s_branch poll_12

poll_12_done:
    v_mov_b32 v6, 163744
    v_mov_b32 v7, 1
    s_mov_b64 exec, 1
    ds_write_b32 v6, v7
    s_mov_b64 exec, -1
    s_branch B_other_11_j
B_other_11:
    v_mov_b32 v7, 163744
    s_mov_b32 s62, 0
spin_13:
    ds_read_b32 v6, v7
    s_add_u32 s62, s62, 1
    s_waitcnt lgkmcnt(0)
    v_readfirstlane_b32 s63, v6
    s_cmp_gt_u32 s62, 524288
    s_cbranch_scc1 spin_13_done
    s_cmp_ge_u32 s63, 1
    s_cbranch_scc1 spin_13_done
    s_sleep 1
    s_branch spin_13

spin_13_done:
B_other_11_j:
    v_mov_b32 v9, 0
    s_mov_b32 s62, 0
kvq_retry_10:
    v_add_u32 v6, 20480, v11
    s_add_u32 m0, s53, 20480
    s_nop 0
    buffer_load_dwordx4 v6, s[4:7], 0 offen sc1 lds
    v_subrev_u32 v6, 4096, v6
    s_add_u32 m0, s53, 16384
    s_nop 0
    buffer_load_dwordx4 v6, s[4:7], 0 offen sc1 lds
    v_subrev_u32 v6, 4096, v6
    s_add_u32 m0, s53, 12288
    s_nop 0
    buffer_load_dwordx4 v6, s[4:7], 0 offen sc1 lds
    v_subrev_u32 v6, 4096, v6
    s_add_u32 m0, s53, 8192
    s_nop 0
    buffer_load_dwordx4 v6, s[4:7], 0 offen sc1 lds
    v_subrev_u32 v6, 4096, v6
    s_add_u32 m0, s53, 4096
    s_nop 0
    buffer_load_dwordx4 v6, s[4:7], 0 offen sc1 lds
    v_subrev_u32 v6, 4096, v6
    s_add_u32 m0, s53, 0
    s_nop 0
    buffer_load_dwordx4 v6, s[4:7], 0 offen sc1 lds
    s_lshl_b32 s23, s39, 13
    s_lshl_b32 s24, s59, 11
    s_add_u32 s23, s23, s24
    s_add_u32 m0, s24, 115712
    s_add_u32 s25, s23, 1024
    buffer_load_dwordx4 v13, s[12:15], s23 offen sc1 lds
    s_add_u32 m0, s24, 116736
    s_nop 0
    buffer_load_dwordx4 v13, s[12:15], s25 offen sc1 lds

    s_waitcnt vmcnt(0)
    ds_read_b32 v24, v19
    s_waitcnt lgkmcnt(0)
    v_cmp_ne_u32 vcc, s3, v24

    ds_read_b32 v22, v18 offset:0
    ds_read_b32 v23, v18 offset:16384
    s_waitcnt lgkmcnt(0)
    v_cmp_ne_u32 s[84:85], v22, v15
    v_cmp_ne_u32 s[86:87], v23, v16
    s_nop 1
    s_mov_b32 s87, 0
    s_or_b64 vcc, vcc, s[84:85]
    s_or_b64 vcc, vcc, s[86:87]

    s_add_u32 s62, s62, 1
    s_cmp_gt_u32 s62, 65536
    s_cbranch_scc1 kvq_retry_10_done
    s_cbranch_vccz kvq_retry_10_done
    s_sleep 4
    s_branch kvq_retry_10
kvq_retry_10_done:
    v_add_u32 v6, 20480, v11
    s_add_u32 m0, s53, 45056
    s_nop 0
    buffer_load_dwordx4 v6, s[8:11], 0 offen sc1 lds
    v_subrev_u32 v6, 4096, v6
    s_add_u32 m0, s53, 40960
    s_nop 0
    buffer_load_dwordx4 v6, s[8:11], 0 offen sc1 lds
    v_subrev_u32 v6, 4096, v6
    s_add_u32 m0, s53, 36864
    s_nop 0
    buffer_load_dwordx4 v6, s[8:11], 0 offen sc1 lds
    v_subrev_u32 v6, 4096, v6
    s_add_u32 m0, s53, 32768
    s_nop 0
    buffer_load_dwordx4 v6, s[8:11], 0 offen sc1 lds
    v_subrev_u32 v6, 4096, v6
    s_add_u32 m0, s53, 28672
    s_nop 0
    buffer_load_dwordx4 v6, s[8:11], 0 offen sc1 lds
    v_subrev_u32 v6, 4096, v6
    s_add_u32 m0, s53, 24576
    s_nop 0
    buffer_load_dwordx4 v6, s[8:11], 0 offen sc1 lds
L_roleB_4_j:
    s_cmp_ge_u32 s39, 2
    s_cbranch_scc1 nopatch_14
    v_lshrrev_b32 v6, 4, v1
    v_and_b32 v7, 1, v6
    v_lshlrev_b32 v7, 1, v7
    v_lshrrev_b32 v8, 1, v6
    v_mul_u32_u24 v8, 3, v8
    v_xor_b32 v7, v7, v8

    v_xor_b32 v7, 3, v7
    v_and_b32 v8, 3, v1
    v_cmp_eq_u32 vcc, v7, v8
    v_add_u32 v6, s53, v13
    v_mov_b32 v8, 0xf14a
    s_and_saveexec_b64 s[60:61], vcc

    ds_write_b32 v6, v8 offset:8
    ds_write_b32 v6, v8 offset:4104
    s_cmp_eq_u32 s39, 1
    s_cbranch_scc1 nopatch_14_r
    ds_write_b32 v6, v8 offset:8200
    ds_write_b32 v6, v8 offset:12296
nopatch_14_r:
    s_mov_b64 exec, s[60:61]
    s_waitcnt lgkmcnt(0)
nopatch_14:
    s_barrier
    s_mov_b32 s62, 0
    s_waitcnt vmcnt(0)
v_retry_15:
    s_mov_b64 vcc, 0
    ds_read_b32 v22, v18 offset:24576
    ds_read_b32 v23, v18 offset:40960
    s_waitcnt lgkmcnt(0)
    v_cmp_ne_u32 s[84:85], v22, v15
    v_cmp_ne_u32 s[86:87], v23, v16
    s_nop 1
    s_mov_b32 s87, 0
    s_or_b64 vcc, vcc, s[84:85]
    s_or_b64 vcc, vcc, s[86:87]

    s_add_u32 s62, s62, 1
    s_cmp_gt_u32 s62, 65536
    s_cbranch_scc1 v_retry_15_done
    s_cbranch_vccz v_retry_15_done
    s_sleep 4
    v_add_u32 v6, 20480, v11
    s_add_u32 m0, s53, 45056
    s_nop 0
    buffer_load_dwordx4 v6, s[8:11], 0 offen sc1 lds
    v_subrev_u32 v6, 4096, v6
    s_add_u32 m0, s53, 40960
    s_nop 0
    buffer_load_dwordx4 v6, s[8:11], 0 offen sc1 lds
    v_subrev_u32 v6, 4096, v6
    s_add_u32 m0, s53, 36864
    s_nop 0
    buffer_load_dwordx4 v6, s[8:11], 0 offen sc1 lds
    v_subrev_u32 v6, 4096, v6
    s_add_u32 m0, s53, 32768
    s_nop 0
    buffer_load_dwordx4 v6, s[8:11], 0 offen sc1 lds
    v_subrev_u32 v6, 4096, v6
    s_add_u32 m0, s53, 28672
    s_nop 0
    buffer_load_dwordx4 v6, s[8:11], 0 offen sc1 lds
    v_subrev_u32 v6, 4096, v6
    s_add_u32 m0, s53, 24576
    s_nop 0
    buffer_load_dwordx4 v6, s[8:11], 0 offen sc1 lds
    s_waitcnt vmcnt(0)
    s_branch v_retry_15
v_retry_15_done:
    v_mov_b32 v6, 163760
    v_mov_b32 v7, 1
    s_mov_b64 exec, 1
    ds_add_u32 v6, v7
    s_mov_b64 exec, -1
    s_cmp_ge_u32 s58, 28
    s_cbranch_scc1 K_FIN
    v_add_u32 v30, 123904, v228
    v_lshrrev_b32 v7, 4, v1
    v_lshl_add_u32 v8, v7, 12, v14
    v_add_u32 v8, s53, v8
    v_add_u32 v9, 107520, v8

    s_mov_b32 s62, 0
spin_16:
    ds_read_b32 v6, v20
    s_add_u32 s62, s62, 1
    s_waitcnt lgkmcnt(0)
    v_readfirstlane_b32 s63, v6
    s_cmp_gt_u32 s62, 524288
    s_cbranch_scc1 spin_16_done
    s_cmp_ge_u32 s63, 4
    s_cbranch_scc1 spin_16_done
    s_sleep 1
    s_branch spin_16

spin_16_done:
    s_cmp_eq_u32 s56, 4
    s_cselect_b32 s16, 1, s19
    s_add_u32 m0, s53, 123904
    s_add_u32 s24, s52, 3145728
    buffer_load_dwordx4 v13, s[92:95], s24 offen sc1 lds
    s_add_u32 m0, s53, 128000
    s_add_u32 s24, s52, 3276800
    buffer_load_dwordx4 v13, s[92:95], s24 offen sc1 lds
    s_add_u32 m0, s53, 132096
    s_add_u32 s24, s52, 3407872
    buffer_load_dwordx4 v13, s[92:95], s24 offen sc1 lds
    s_add_u32 m0, s53, 136192
    s_add_u32 s24, s52, 3538944
    buffer_load_dwordx4 v13, s[92:95], s24 offen sc1 lds
    s_add_u32 m0, s53, 140288
    s_add_u32 s24, s52, 3670016
    buffer_load_dwordx4 v13, s[92:95], s24 offen sc1 lds
    s_add_u32 m0, s53, 144384
    s_add_u32 s24, s52, 3801088
    buffer_load_dwordx4 v13, s[92:95], s24 offen sc1 lds
    s_add_u32 m0, s53, 148480
    s_add_u32 s24, s52, 3932160
    buffer_load_dwordx4 v13, s[92:95], s24 offen sc1 lds
    s_add_u32 m0, s53, 152576
    s_add_u32 s24, s52, 4063232
    buffer_load_dwordx4 v13, s[92:95], s24 offen sc1 lds
    s_cmp_eq_u32 s16, 0
    s_cbranch_scc1 obl_light_17
    s_cmp_eq_u32 s59, 3
    s_cselect_b32 exec_hi, 0, -1
    s_add_u32 m0, s53, 77824
    s_mov_b32 s23, 200704
    buffer_load_dwordx4 v235, s[44:47], s23 offen lds
    s_add_u32 m0, s53, 81408
    s_mov_b32 s23, 225792
    buffer_load_dwordx4 v235, s[44:47], s23 offen lds
    s_add_u32 m0, s53, 84992
    s_mov_b32 s23, 250880
    buffer_load_dwordx4 v235, s[44:47], s23 offen lds
    s_add_u32 m0, s53, 88576
    s_mov_b32 s23, 275968
    buffer_load_dwordx4 v235, s[44:47], s23 offen lds
    s_add_u32 m0, s53, 92160
    s_mov_b32 s23, 301056
    buffer_load_dwordx4 v235, s[44:47], s23 offen lds
    s_add_u32 m0, s53, 95744
    s_mov_b32 s23, 326144
    buffer_load_dwordx4 v235, s[44:47], s23 offen lds
    s_add_u32 m0, s53, 99328
    s_mov_b32 s23, 351232
    buffer_load_dwordx4 v235, s[44:47], s23 offen lds
    s_mov_b32 exec_hi, -1
    s_add_u32 m0, s53, 102912
    s_mov_b32 s23, 376320
    buffer_load_dwordx4 v236, s[44:47], s23 offen lds
    s_add_u32 m0, s53, 0
    s_add_u32 s24, s52, 2097152
    buffer_load_dwordx4 v13, s[92:95], s24 offen sc1 lds
    s_add_u32 m0, s53, 4096
    s_add_u32 s24, s52, 2228224
    buffer_load_dwordx4 v13, s[92:95], s24 offen sc1 lds
    s_add_u32 m0, s53, 8192
    s_add_u32 s24, s52, 2359296
    buffer_load_dwordx4 v13, s[92:95], s24 offen sc1 lds
    s_add_u32 m0, s53, 12288
    s_add_u32 s24, s52, 2490368
    buffer_load_dwordx4 v13, s[92:95], s24 offen sc1 lds
    s_add_u32 m0, s53, 107520
    s_add_u32 s24, s52, 2621440
    buffer_load_dwordx4 v13, s[92:95], s24 offen sc1 lds
    s_add_u32 m0, s53, 111616
    s_add_u32 s24, s52, 2752512
    buffer_load_dwordx4 v13, s[92:95], s24 offen sc1 lds
    s_add_u32 m0, s53, 115712
    s_add_u32 s24, s52, 2883584
    buffer_load_dwordx4 v13, s[92:95], s24 offen sc1 lds
    s_add_u32 m0, s53, 119808
    s_add_u32 s24, s52, 3014656
    buffer_load_dwordx4 v13, s[92:95], s24 offen sc1 lds
    s_cmp_eq_u32 s59, 3
    s_cselect_b32 exec_hi, 0, -1
    s_add_u32 m0, s53, 49152
    s_mov_b32 s23, 0
    buffer_load_dwordx4 v235, s[44:47], s23 offen lds
    s_add_u32 m0, s53, 52736
    s_mov_b32 s23, 25088
    buffer_load_dwordx4 v235, s[44:47], s23 offen lds
    s_add_u32 m0, s53, 56320
    s_mov_b32 s23, 50176
    buffer_load_dwordx4 v235, s[44:47], s23 offen lds
    s_add_u32 m0, s53, 59904
    s_mov_b32 s23, 75264
    buffer_load_dwordx4 v235, s[44:47], s23 offen lds
    s_add_u32 m0, s53, 63488
    s_mov_b32 s23, 100352
    buffer_load_dwordx4 v235, s[44:47], s23 offen lds
    s_add_u32 m0, s53, 67072
    s_mov_b32 s23, 125440
    buffer_load_dwordx4 v235, s[44:47], s23 offen lds
    s_add_u32 m0, s53, 70656
    s_mov_b32 s23, 150528
    buffer_load_dwordx4 v235, s[44:47], s23 offen lds
    s_add_u32 m0, s53, 74240
    s_mov_b32 s23, 175616
    buffer_load_dwordx4 v235, s[44:47], s23 offen lds
    s_mov_b32 exec_hi, -1
    s_waitcnt vmcnt(16)
    s_branch obl_light_17_j
obl_light_17:
    s_add_u32 m0, s53, 0
    s_add_u32 s24, s52, 2097152
    buffer_load_dwordx4 v13, s[92:95], s24 offen sc1 lds
    s_add_u32 m0, s53, 4096
    s_add_u32 s24, s52, 2228224
    buffer_load_dwordx4 v13, s[92:95], s24 offen sc1 lds
    s_add_u32 m0, s53, 8192
    s_add_u32 s24, s52, 2359296
    buffer_load_dwordx4 v13, s[92:95], s24 offen sc1 lds
    s_add_u32 m0, s53, 12288
    s_add_u32 s24, s52, 2490368
    buffer_load_dwordx4 v13, s[92:95], s24 offen sc1 lds
    s_add_u32 m0, s53, 107520
    s_add_u32 s24, s52, 2621440
    buffer_load_dwordx4 v13, s[92:95], s24 offen sc1 lds
    s_add_u32 m0, s53, 111616
    s_add_u32 s24, s52, 2752512
    buffer_load_dwordx4 v13, s[92:95], s24 offen sc1 lds
    s_add_u32 m0, s53, 115712
    s_add_u32 s24, s52, 2883584
    buffer_load_dwordx4 v13, s[92:95], s24 offen sc1 lds
    s_add_u32 m0, s53, 119808
    s_add_u32 s24, s52, 3014656
    buffer_load_dwordx4 v13, s[92:95], s24 offen sc1 lds
    s_cmp_eq_u32 s59, 3
    s_cselect_b32 exec_hi, 0, -1
    s_add_u32 m0, s53, 49152
    s_mov_b32 s23, 0
    buffer_load_dwordx4 v235, s[44:47], s23 offen lds
    s_add_u32 m0, s53, 52736
    s_mov_b32 s23, 25088
    buffer_load_dwordx4 v235, s[44:47], s23 offen lds
    s_add_u32 m0, s53, 56320
    s_mov_b32 s23, 50176
    buffer_load_dwordx4 v235, s[44:47], s23 offen lds
    s_mov_b32 exec_hi, -1
    s_waitcnt vmcnt(11)
obl_light_17_j:
    s_mov_b32 s62, 0
obh_retry_18:
    ds_read_b128 v[76:79], v30 offset:0
    ds_read_b128 v[80:83], v30 offset:4096
    ds_read_b128 v[84:87], v30 offset:8192
    ds_read_b128 v[88:91], v30 offset:12288
    ds_read_b128 v[92:95], v30 offset:16384
    ds_read_b128 v[96:99], v30 offset:20480
    ds_read_b128 v[100:103], v30 offset:24576
    ds_read_b128 v[104:107], v30 offset:28672
    s_waitcnt lgkmcnt(0)
    v_cmp_ne_u32 vcc, s3, v79
    v_cmp_ne_u32 s[86:87], s3, v83
    s_or_b64 vcc, vcc, s[86:87]
    v_cmp_ne_u32 s[86:87], s3, v87
    s_or_b64 vcc, vcc, s[86:87]
    v_cmp_ne_u32 s[86:87], s3, v91
    s_or_b64 vcc, vcc, s[86:87]
    v_cmp_ne_u32 s[86:87], s3, v95
    s_or_b64 vcc, vcc, s[86:87]
    v_cmp_ne_u32 s[86:87], s3, v99
    s_or_b64 vcc, vcc, s[86:87]
    v_cmp_ne_u32 s[86:87], s3, v103
    s_or_b64 vcc, vcc, s[86:87]
    v_cmp_ne_u32 s[86:87], s3, v107
    s_or_b64 vcc, vcc, s[86:87]
    s_and_b32 vcc_hi, vcc_hi, 0xffff0000
    s_mov_b32 vcc_lo, 0
    s_add_u32 s62, s62, 1
    s_cmp_gt_u32 s62, 65536
    s_cbranch_scc1 obh_retry_18_done
    s_cbranch_vccz obh_retry_18_done
    s_sleep 8

    s_add_u32 m0, s53, 123904
    s_add_u32 s24, s52, 3145728
    buffer_load_dwordx4 v13, s[92:95], s24 offen sc1 lds
    s_add_u32 m0, s53, 128000
    s_add_u32 s24, s52, 3276800
    buffer_load_dwordx4 v13, s[92:95], s24 offen sc1 lds
    s_add_u32 m0, s53, 132096
    s_add_u32 s24, s52, 3407872
    buffer_load_dwordx4 v13, s[92:95], s24 offen sc1 lds
    s_add_u32 m0, s53, 136192
    s_add_u32 s24, s52, 3538944
    buffer_load_dwordx4 v13, s[92:95], s24 offen sc1 lds
    s_add_u32 m0, s53, 140288
    s_add_u32 s24, s52, 3670016
    buffer_load_dwordx4 v13, s[92:95], s24 offen sc1 lds
    s_add_u32 m0, s53, 144384
    s_add_u32 s24, s52, 3801088
    buffer_load_dwordx4 v13, s[92:95], s24 offen sc1 lds
    s_add_u32 m0, s53, 148480
    s_add_u32 s24, s52, 3932160
    buffer_load_dwordx4 v13, s[92:95], s24 offen sc1 lds
    s_add_u32 m0, s53, 152576
    s_add_u32 s24, s52, 4063232
    buffer_load_dwordx4 v13, s[92:95], s24 offen sc1 lds
    s_waitcnt vmcnt(0)
    s_branch obh_retry_18
obh_retry_18_done:
    v_cmp_gt_u32 vcc, 48, v1
    s_nop 1
    v_cndmask_b32 v79, 0, v79, vcc
    v_cndmask_b32 v83, 0, v83, vcc
    v_cndmask_b32 v87, 0, v87, vcc
    v_cndmask_b32 v91, 0, v91, vcc
    v_cndmask_b32 v95, 0, v95, vcc
    v_cndmask_b32 v99, 0, v99, vcc
    v_cndmask_b32 v103, 0, v103, vcc
    v_cndmask_b32 v107, 0, v107, vcc
    s_mov_b32 s62, 0
obl_retry_19:
    s_waitcnt vmcnt(0)
    ds_read_b32 v22, v8
    ds_read_b32 v23, v9
    s_waitcnt lgkmcnt(0)
    v_cmp_ne_u32 vcc, s3, v22
    v_cmp_ne_u32 s[84:85], s3, v23
    s_add_u32 s62, s62, 1
    s_nop 1
    s_or_b64 vcc, vcc, s[84:85]
    s_cmp_gt_u32 s62, 65536
    s_cbranch_scc1 obl_retry_19_done
    s_cbranch_vccz obl_retry_19_done
    s_sleep 8

    s_add_u32 m0, s53, 0
    s_add_u32 s24, s52, 2097152
    buffer_load_dwordx4 v13, s[92:95], s24 offen sc1 lds
    s_add_u32 m0, s53, 4096
    s_add_u32 s24, s52, 2228224
    buffer_load_dwordx4 v13, s[92:95], s24 offen sc1 lds
    s_add_u32 m0, s53, 8192
    s_add_u32 s24, s52, 2359296
    buffer_load_dwordx4 v13, s[92:95], s24 offen sc1 lds
    s_add_u32 m0, s53, 12288
    s_add_u32 s24, s52, 2490368
    buffer_load_dwordx4 v13, s[92:95], s24 offen sc1 lds
    s_add_u32 m0, s53, 107520
    s_add_u32 s24, s52, 2621440
    buffer_load_dwordx4 v13, s[92:95], s24 offen sc1 lds
    s_add_u32 m0, s53, 111616
    s_add_u32 s24, s52, 2752512
    buffer_load_dwordx4 v13, s[92:95], s24 offen sc1 lds
    s_add_u32 m0, s53, 115712
    s_add_u32 s24, s52, 2883584
    buffer_load_dwordx4 v13, s[92:95], s24 offen sc1 lds
    s_add_u32 m0, s53, 119808
    s_add_u32 s24, s52, 3014656
    buffer_load_dwordx4 v13, s[92:95], s24 offen sc1 lds
    s_branch obl_retry_19
obl_retry_19_done:
    s_branch P3_START
COMPUTE:
    s_or_b32 s60, s56, s2
    s_cmp_lg_u32 s60, 0
    s_cbranch_scc1 TAG_skip
    s_memrealtime s[60:61]
    s_waitcnt lgkmcnt(0)
    s_lshr_b32 s61, s60, 14
    s_and_b32 s61, s61, 0x3fff
    s_lshl_b32 s61, s61, 16
    s_and_b32 s60, s60, 0x3fff
    s_or_b32 s60, s60, s61
    s_or_b32 s60, s60, 1
    v_mov_b32 v2, 0
    v_mov_b32 v3, s60
    s_mov_b64 exec, 1
    global_store_dword v2, v3, s[80:81] sc1
    s_mov_b64 exec, -1

TAG_skip:
    s_lshr_b32 s19, s58, 4
    s_lshr_b32 s17, s57, 2
    s_lshl_b32 s17, s17, 3
    s_bfe_u32 s25, s58, 0x30001
    s_add_u32 s17, s17, s25
    s_and_b32 s18, s57, 3
    s_lshl_b32 s18, s18, 1
    s_and_b32 s24, s58, 1
    s_add_u32 s18, s18, s24
    s_lshl_b32 s33, s24, 1
    s_add_u32 s33, s33, s25
    s_lshl_b32 s23, s19, 2
    s_add_u32 s33, s33, s23
    s_cmp_ge_u32 s33, 7
    s_cselect_b32 s25, 7, 0
    s_sub_u32 s33, s33, s25

    s_cmp_eq_u32 s19, 1
    s_cbranch_scc1 P1_B
    v_lshrrev_b32 v8, 4, v1
    v_and_b32 v9, 1, v8
    v_lshlrev_b32 v9, 3, v9
    v_lshrrev_b32 v10, 1, v8
    v_add_u32 v9, v9, v10
    v_bfe_u32 v10, v1, 2, 2
    v_lshlrev_b32 v10, 1, v10
    v_add_u32 v9, v9, v10
    v_mul_u32_u24 v9, 112, v9
    v_and_b32 v10, 3, v1
    v_lshlrev_b32 v11, 3, v10
    v_add_u32 v6, v9, v11
    v_add_u32 v7, 96, v6
    v_add_u32 v11, 7168, v6
    v_cmp_lt_u32 vcc, 1, v10
    v_and_b32 v9, 15, v1
    v_lshrrev_b32 v10, 1, v9
    v_cndmask_b32 v7, v7, v11, vcc
    v_xor_b32 v10, v10, v8
    v_lshlrev_b32 v10, 4, v10
    v_lshlrev_b32 v9, 7, v9
    v_add_u32 v26, v9, v10
    v_add_u32 v26, 21552, v26
    v_xor_b32 v10, 64, v10
    v_add_u32 v27, v9, v10
    v_add_u32 v27, 21552, v27
    s_lshl_b32 s23, s56, 12
    s_add_u32 s23, s23, 0
    v_add_u32 v24, s23, v26
    v_add_u32 v25, s23, v27
    v_lshlrev_b32 v28, 4, v8

    v_and_b32 v8, 15, v1
    s_lshl_b32 s23, s56, 5
    v_add_u32 v9, s23, v8
    v_lshlrev_b32 v23, 6, v9
    v_add_u32 v23, 0, v23
    v_lshrrev_b32 v8, 2, v8

    v_and_b32 v9, 1, v8
    v_lshlrev_b32 v9, 1, v9
    v_lshrrev_b32 v10, 1, v8
    v_mul_u32_u24 v10, 3, v10
    v_xor_b32 v9, v9, v10

    v_lshrrev_b32 v8, 4, v1
    v_add_u32 v10, 0, v8
    v_mul_u32_u24 v11, 37, v10
    v_lshrrev_b32 v11, 8, v11
    v_mul_u32_u24 v12, 7, v11
    v_sub_u32 v10, v10, v12
    v_mul_u32_u24 v11, 8192, v11
    v_add_u32 v11, v11, v23
    v_lshrrev_b32 v12, 1, v10
    v_xor_b32 v12, v12, v9
    v_lshl_add_u32 v12, v12, 4, v11
    v_and_b32 v10, 1, v10
    v_lshl_add_u32 v12, v10, 3, v12

    v_add_u32 v10, 4, v8
    v_mul_u32_u24 v11, 37, v10
    v_lshrrev_b32 v11, 8, v11
    v_mul_u32_u24 v13, 7, v11
    v_sub_u32 v10, v10, v13
    v_mul_u32_u24 v11, 8192, v11
    v_add_u32 v11, v11, v23
    v_lshrrev_b32 v13, 1, v10
    v_xor_b32 v13, v13, v9
    v_lshl_add_u32 v13, v13, 4, v11
    v_and_b32 v10, 1, v10
    v_lshl_add_u32 v13, v10, 3, v13

    v_add_u32 v10, 8, v8
    v_mul_u32_u24 v11, 37, v10
    v_lshrrev_b32 v11, 8, v11
    v_mul_u32_u24 v14, 7, v11
    v_sub_u32 v10, v10, v14
    v_mul_u32_u24 v11, 8192, v11
    v_add_u32 v11, v11, v23
    v_lshrrev_b32 v14, 1, v10
    v_xor_b32 v14, v14, v9
    v_lshl_add_u32 v14, v14, 4, v11
    v_and_b32 v10, 1, v10
    v_lshl_add_u32 v14, v10, 3, v14

    v_add_u32 v10, 12, v8
    v_mul_u32_u24 v11, 37, v10
    v_lshrrev_b32 v11, 8, v11
    v_mul_u32_u24 v15, 7, v11
    v_sub_u32 v10, v10, v15
    v_mul_u32_u24 v11, 8192, v11
    v_add_u32 v11, v11, v23
    v_lshrrev_b32 v15, 1, v10
    v_xor_b32 v15, v15, v9
    v_lshl_add_u32 v15, v15, 4, v11
    v_and_b32 v10, 1, v10
    v_lshl_add_u32 v15, v10, 3, v15

    v_add_u32 v10, 16, v8
    v_mul_u32_u24 v11, 37, v10
    v_lshrrev_b32 v11, 8, v11
    v_mul_u32_u24 v16, 7, v11
    v_sub_u32 v10, v10, v16
    v_mul_u32_u24 v11, 8192, v11
    v_add_u32 v11, v11, v23
    v_lshrrev_b32 v16, 1, v10
    v_xor_b32 v16, v16, v9
    v_lshl_add_u32 v16, v16, 4, v11
    v_and_b32 v10, 1, v10
    v_lshl_add_u32 v16, v10, 3, v16

    v_add_u32 v10, 20, v8
    v_mul_u32_u24 v11, 37, v10
    v_lshrrev_b32 v11, 8, v11
    v_mul_u32_u24 v17, 7, v11
    v_sub_u32 v10, v10, v17
    v_mul_u32_u24 v11, 8192, v11
    v_add_u32 v11, v11, v23
    v_lshrrev_b32 v17, 1, v10
    v_xor_b32 v17, v17, v9
    v_lshl_add_u32 v17, v17, 4, v11
    v_and_b32 v10, 1, v10
    v_lshl_add_u32 v17, v10, 3, v17

    v_add_u32 v10, 24, v8
    v_mul_u32_u24 v11, 37, v10
    v_lshrrev_b32 v11, 8, v11
    v_mul_u32_u24 v18, 7, v11
    v_sub_u32 v10, v10, v18
    v_mul_u32_u24 v11, 8192, v11
    v_add_u32 v11, v11, v23
    v_lshrrev_b32 v18, 1, v10
    v_xor_b32 v18, v18, v9
    v_lshl_add_u32 v18, v18, 4, v11
    v_and_b32 v10, 1, v10
    v_lshl_add_u32 v18, v10, 3, v18

    v_add_u32 v10, 28, v8
    v_mul_u32_u24 v11, 37, v10
    v_lshrrev_b32 v11, 8, v11
    v_mul_u32_u24 v19, 7, v11
    v_sub_u32 v10, v10, v19
    v_mul_u32_u24 v11, 8192, v11
    v_add_u32 v11, v11, v23
    v_lshrrev_b32 v19, 1, v10
    v_xor_b32 v19, v19, v9
    v_lshl_add_u32 v19, v19, 4, v11
    v_and_b32 v10, 1, v10
    v_lshl_add_u32 v19, v10, 3, v19

    v_add_u32 v10, 32, v8
    v_mul_u32_u24 v11, 37, v10
    v_lshrrev_b32 v11, 8, v11
    v_mul_u32_u24 v20, 7, v11
    v_sub_u32 v10, v10, v20
    v_mul_u32_u24 v11, 8192, v11
    v_add_u32 v11, v11, v23
    v_lshrrev_b32 v20, 1, v10
    v_xor_b32 v20, v20, v9
    v_lshl_add_u32 v20, v20, 4, v11
    v_and_b32 v10, 1, v10
    v_lshl_add_u32 v20, v10, 3, v20

    v_add_u32 v10, 36, v8
    v_mul_u32_u24 v11, 37, v10
    v_lshrrev_b32 v11, 8, v11
    v_mul_u32_u24 v21, 7, v11
    v_sub_u32 v10, v10, v21
    v_mul_u32_u24 v11, 8192, v11
    v_add_u32 v11, v11, v23
    v_lshrrev_b32 v21, 1, v10
    v_xor_b32 v21, v21, v9
    v_lshl_add_u32 v21, v21, 4, v11
    v_and_b32 v10, 1, v10
    v_lshl_add_u32 v21, v10, 3, v21

    v_add_u32 v10, 40, v8
    v_mul_u32_u24 v11, 37, v10
    v_lshrrev_b32 v11, 8, v11
    v_mul_u32_u24 v22, 7, v11
    v_sub_u32 v10, v10, v22
    v_mul_u32_u24 v11, 8192, v11
    v_add_u32 v11, v11, v23
    v_lshrrev_b32 v22, 1, v10
    v_xor_b32 v22, v22, v9
    v_lshl_add_u32 v22, v22, 4, v11
    v_and_b32 v10, 1, v10
    v_lshl_add_u32 v22, v10, 3, v22

    v_and_b32 v8, 31, v1
    v_bfe_u32 v9, v1, 2, 2

    v_and_b32 v10, 1, v9
    v_lshlrev_b32 v10, 1, v10
    v_lshrrev_b32 v11, 1, v9
    v_mul_u32_u24 v11, 3, v11
    v_xor_b32 v10, v10, v11

    v_xor_b32 v10, 3, v10
    v_lshlrev_b32 v10, 4, v10
    s_lshl_b32 s23, s56, 5
    v_add_u32 v8, s23, v8
    v_lshl_add_u32 v10, v8, 6, v10
    v_lshrrev_b32 v9, 5, v1
    v_mul_u32_u24 v11, 8192, v9
    v_add_u32 v23, v10, v11
    v_add_u32 v23, 8, v23

    s_mul_i32 s23, s18, 6
    s_add_u32 s23, s23, 0
    v_add_u32 v8, s23, v9
    v_lshrrev_b32 v8, 4, v8
    v_cmp_ne_u32 vcc, 1, v8
    v_mov_b32 v11, 0x3f80
    s_nop 0
    v_cndmask_b32 v2, 0, v11, vcc

    s_mul_i32 s23, s18, 6
    s_add_u32 s23, s23, 2
    v_add_u32 v8, s23, v9
    v_lshrrev_b32 v8, 4, v8
    v_cmp_ne_u32 vcc, 1, v8
    v_mov_b32 v11, 0x3f80
    s_nop 0
    v_cndmask_b32 v3, 0, v11, vcc

    s_mul_i32 s23, s18, 6
    s_add_u32 s23, s23, 4
    v_add_u32 v8, s23, v9
    v_lshrrev_b32 v8, 4, v8
    v_cmp_ne_u32 vcc, 1, v8
    v_mov_b32 v11, 0x3f80
    s_nop 0
    v_cndmask_b32 v4, 0, v11, vcc

    v_mov_b32 v100, 0
    v_mov_b32 v101, 0
    v_mov_b32 v102, 0
    v_mov_b32 v103, 0
    v_mov_b32 v104, 0
    v_mov_b32 v105, 0
    v_mov_b32 v106, 0
    v_mov_b32 v107, 0
    v_mov_b32 v108, 0
    v_mov_b32 v109, 0
    v_mov_b32 v110, 0
    v_mov_b32 v111, 0
    v_mov_b32 v112, 0
    v_mov_b32 v113, 0
    v_mov_b32 v114, 0
    v_mov_b32 v115, 0
    v_mov_b32 v116, 0
    v_mov_b32 v117, 0
    v_mov_b32 v118, 0
    v_mov_b32 v119, 0
    v_mov_b32 v120, 0
    v_mov_b32 v121, 0
    v_mov_b32 v122, 0
    v_mov_b32 v123, 0
    v_mov_b32 v124, 0
    v_mov_b32 v125, 0
    v_mov_b32 v126, 0
    v_mov_b32 v127, 0
    v_mov_b32 v128, 0
    v_mov_b32 v129, 0
    v_mov_b32 v130, 0
    v_mov_b32 v131, 0
    v_mov_b32 v132, 0
    v_mov_b32 v133, 0
    v_mov_b32 v134, 0
    v_mov_b32 v135, 0
    v_mov_b32 v136, 0
    v_mov_b32 v137, 0
    v_mov_b32 v138, 0
    v_mov_b32 v139, 0
    v_mov_b32 v140, 0
    v_mov_b32 v141, 0
    v_mov_b32 v142, 0
    v_mov_b32 v143, 0
    v_mov_b32 v144, 0
    v_mov_b32 v145, 0
    v_mov_b32 v146, 0
    v_mov_b32 v147, 0
    v_mov_b32 v148, 0
    v_mov_b32 v149, 0
    v_mov_b32 v150, 0
    v_mov_b32 v151, 0
    v_mov_b32 v152, 0
    v_mov_b32 v153, 0
    v_mov_b32 v154, 0
    v_mov_b32 v155, 0
    v_mov_b32 v156, 0
    v_mov_b32 v157, 0
    v_mov_b32 v158, 0
    v_mov_b32 v159, 0
    v_mov_b32 v160, 0
    v_mov_b32 v161, 0
    v_mov_b32 v162, 0
    v_mov_b32 v163, 0
    v_mov_b32 v164, 0
    v_mov_b32 v165, 0
    v_mov_b32 v166, 0
    v_mov_b32 v167, 0
    v_mov_b32 v168, 0
    v_mov_b32 v169, 0
    v_mov_b32 v170, 0
    v_mov_b32 v171, 0
    v_mov_b32 v172, 0
    v_mov_b32 v173, 0
    v_mov_b32 v174, 0
    v_mov_b32 v175, 0
    v_mov_b32 v176, 0
    v_mov_b32 v177, 0
    v_mov_b32 v178, 0
    v_mov_b32 v179, 0
    v_mov_b32 v180, 0
    v_mov_b32 v181, 0
    v_mov_b32 v182, 0
    v_mov_b32 v183, 0
    v_mov_b32 v184, 0
    v_mov_b32 v185, 0
    v_mov_b32 v186, 0
    v_mov_b32 v187, 0
    v_mov_b32 v188, 0
    v_mov_b32 v189, 0
    v_mov_b32 v190, 0
    v_mov_b32 v191, 0
    v_mov_b32 v192, 0
    v_mov_b32 v193, 0
    v_mov_b32 v194, 0
    v_mov_b32 v195, 0
    s_mov_b32 s34, 1
    s_mov_b32 s36, 0
    v_add_u32 v6, 37936, v6
    v_add_u32 v7, 37936, v7
    v_add_u32 v24, 37936, v24
    v_add_u32 v25, 37936, v25
    s_lshr_b32 s35, s18, 1
    s_cmp_eq_u32 s35, s56
    s_cselect_b64 vcc, -1, 0
    s_lshl_b32 s35, s33, 7
    s_add_u32 s35, s35, 151744
    v_add_u32 v28, s35, v28
    s_waitcnt lgkmcnt(0)
    s_barrier
    v_mov_b32 v29, 0
    global_load_dword v29, v29, s[80:81] sc1
    ds_read_b128 v[76:79], v24 offset:0
    ds_read_b128 v[80:83], v24 offset:2048
    ds_read_b128 v[92:95], v28 offset:0
    ds_read_b64_tr_b16 v[32:33], v6 offset:0
    ds_read_b64_tr_b16 v[34:35], v6 offset:1792
    ds_read_b64_tr_b16 v[36:37], v6 offset:32
    ds_read_b64_tr_b16 v[38:39], v6 offset:1824
    ds_read_b64_tr_b16 v[40:41], v6 offset:64
    ds_read_b64_tr_b16 v[42:43], v6 offset:1856
    ds_read_b64_tr_b16 v[44:45], v7 offset:0
    ds_read_b64_tr_b16 v[46:47], v7 offset:1792
    ds_read_b64_tr_b16 v[48:49], v6 offset:7200
    ds_read_b64_tr_b16 v[50:51], v6 offset:8992
P1_loop_20:
    s_waitcnt lgkmcnt(8)
    v_mfma_f32_16x16x32_bf16 v[100:103], v[32:35], v[76:79], v[100:103]
    ds_read_b64_tr_b16 v[52:53], v6 offset:7232
    v_mfma_f32_16x16x32_bf16 v[144:147], v[32:35], v[80:83], v[144:147]
    ds_read_b64_tr_b16 v[54:55], v6 offset:9024
    s_waitcnt lgkmcnt(8)
    v_mfma_f32_16x16x32_bf16 v[104:107], v[36:39], v[76:79], v[104:107]
    ds_read_b64_tr_b16 v[56:57], v6 offset:7264
    v_mfma_f32_16x16x32_bf16 v[148:151], v[36:39], v[80:83], v[148:151]
    ds_read_b64_tr_b16 v[58:59], v6 offset:9056
    s_add_u32 s34, s34, 1
    s_and_b32 s34, s34, 3
    s_waitcnt lgkmcnt(8)
    v_mfma_f32_16x16x32_bf16 v[108:111], v[40:43], v[76:79], v[108:111]
    ds_read_b64_tr_b16 v[60:61], v6 offset:14368
    v_mfma_f32_16x16x32_bf16 v[152:155], v[40:43], v[80:83], v[152:155]
    ds_read_b64_tr_b16 v[62:63], v6 offset:16160
    s_cmp_eq_u32 s34, 0
    s_mov_b32 s35, 37936
    s_cselect_b32 s35, 0xfffe4370, s35
    s_waitcnt lgkmcnt(8)
    v_mfma_f32_16x16x32_bf16 v[112:115], v[44:47], v[76:79], v[112:115]
    ds_read_b64_tr_b16 v[64:65], v6 offset:14400
    v_mfma_f32_16x16x32_bf16 v[156:159], v[44:47], v[80:83], v[156:159]
    ds_read_b64_tr_b16 v[66:67], v6 offset:16192
    s_add_u32 s33, s33, 1
    s_cmp_eq_u32 s33, 7
    s_cselect_b32 s33, 0, s33
    s_waitcnt lgkmcnt(8)
    v_mfma_f32_16x16x32_bf16 v[116:119], v[48:51], v[76:79], v[116:119]
    ds_read_b64_tr_b16 v[68:69], v6 offset:14432
    v_mfma_f32_16x16x32_bf16 v[160:163], v[48:51], v[80:83], v[160:163]
    ds_read_b64_tr_b16 v[70:71], v6 offset:16224
    s_lshl_b32 s37, s33, 7
    s_add_u32 s37, s37, 151744
    s_waitcnt lgkmcnt(8)
    v_mfma_f32_16x16x32_bf16 v[120:123], v[52:55], v[76:79], v[120:123]
    ds_read_b64_tr_b16 v[72:73], v6 offset:14464
    v_mfma_f32_16x16x32_bf16 v[164:167], v[52:55], v[80:83], v[164:167]
    ds_read_b64_tr_b16 v[74:75], v6 offset:16256
    s_cbranch_vccz gate_s_21
    s_bitcmp1_b32 s18, 0
    s_cbranch_scc1 gate_s_21_1
    v_mfma_f32_16x16x32_bf16 v[188:191], v[92:95], v[76:79], v[188:191]
    s_branch gate_s_21
gate_s_21_1:
    v_mfma_f32_16x16x32_bf16 v[192:195], v[92:95], v[80:83], v[192:195]
gate_s_21:
    ds_read_b128 v[84:87], v25 offset:0
    ds_read_b128 v[88:91], v25 offset:2048
    ds_read_b128 v[96:99], v28 offset:64
    s_waitcnt lgkmcnt(11)
    v_mfma_f32_16x16x32_bf16 v[124:127], v[56:59], v[76:79], v[124:127]
    ds_read_b64_tr_b16 v[32:33], v6 offset:3584
    v_mfma_f32_16x16x32_bf16 v[168:171], v[56:59], v[80:83], v[168:171]
    ds_read_b64_tr_b16 v[34:35], v6 offset:5376
    s_waitcnt lgkmcnt(11)
    v_mfma_f32_16x16x32_bf16 v[128:131], v[60:63], v[76:79], v[128:131]
    ds_read_b64_tr_b16 v[36:37], v6 offset:3616
    v_mfma_f32_16x16x32_bf16 v[172:175], v[60:63], v[80:83], v[172:175]
    ds_read_b64_tr_b16 v[38:39], v6 offset:5408
    v_add_u32 v24, s35, v24
    v_add_u32 v25, s35, v25
    s_waitcnt lgkmcnt(11)
    v_mfma_f32_16x16x32_bf16 v[132:135], v[64:67], v[76:79], v[132:135]
    ds_read_b64_tr_b16 v[40:41], v6 offset:3648
    v_mfma_f32_16x16x32_bf16 v[176:179], v[64:67], v[80:83], v[176:179]
    ds_read_b64_tr_b16 v[42:43], v6 offset:5440
    v_and_b32 v28, 63, v28
    v_add_u32 v28, s37, v28
    s_waitcnt lgkmcnt(11)
    v_mfma_f32_16x16x32_bf16 v[136:139], v[68:71], v[76:79], v[136:139]
    ds_read_b64_tr_b16 v[44:45], v7 offset:3584
    v_mfma_f32_16x16x32_bf16 v[180:183], v[68:71], v[80:83], v[180:183]
    ds_read_b64_tr_b16 v[46:47], v7 offset:5376
    s_waitcnt lgkmcnt(11)
    v_mfma_f32_16x16x32_bf16 v[140:143], v[72:75], v[76:79], v[140:143]
    ds_read_b64_tr_b16 v[48:49], v6 offset:10784
    v_mfma_f32_16x16x32_bf16 v[184:187], v[72:75], v[80:83], v[184:187]
    ds_read_b64_tr_b16 v[50:51], v6 offset:12576
    v_add_u32 v7, s35, v7
    s_waitcnt lgkmcnt(8)
    v_mfma_f32_16x16x32_bf16 v[100:103], v[32:35], v[84:87], v[100:103]
    ds_read_b64_tr_b16 v[52:53], v6 offset:10816
    v_mfma_f32_16x16x32_bf16 v[144:147], v[32:35], v[88:91], v[144:147]
    ds_read_b64_tr_b16 v[54:55], v6 offset:12608
    s_waitcnt lgkmcnt(8)
    v_mfma_f32_16x16x32_bf16 v[104:107], v[36:39], v[84:87], v[104:107]
    ds_read_b64_tr_b16 v[56:57], v6 offset:10848
    v_mfma_f32_16x16x32_bf16 v[148:151], v[36:39], v[88:91], v[148:151]
    ds_read_b64_tr_b16 v[58:59], v6 offset:12640
    s_waitcnt lgkmcnt(8)
    v_mfma_f32_16x16x32_bf16 v[108:111], v[40:43], v[84:87], v[108:111]
    ds_read_b64_tr_b16 v[60:61], v6 offset:17952
    v_mfma_f32_16x16x32_bf16 v[152:155], v[40:43], v[88:91], v[152:155]
    ds_read_b64_tr_b16 v[62:63], v6 offset:19744
    s_waitcnt lgkmcnt(8)
    v_mfma_f32_16x16x32_bf16 v[112:115], v[44:47], v[84:87], v[112:115]
    ds_read_b64_tr_b16 v[64:65], v6 offset:17984
    v_mfma_f32_16x16x32_bf16 v[156:159], v[44:47], v[88:91], v[156:159]
    ds_read_b64_tr_b16 v[66:67], v6 offset:19776
    s_waitcnt lgkmcnt(8)
    v_mfma_f32_16x16x32_bf16 v[116:119], v[48:51], v[84:87], v[116:119]
    ds_read_b64_tr_b16 v[68:69], v6 offset:18016
    v_mfma_f32_16x16x32_bf16 v[160:163], v[48:51], v[88:91], v[160:163]
    ds_read_b64_tr_b16 v[70:71], v6 offset:19808
    s_waitcnt lgkmcnt(8)
    v_mfma_f32_16x16x32_bf16 v[120:123], v[52:55], v[84:87], v[120:123]
    ds_read_b64_tr_b16 v[72:73], v6 offset:18048
    v_mfma_f32_16x16x32_bf16 v[164:167], v[52:55], v[88:91], v[164:167]
    ds_read_b64_tr_b16 v[74:75], v6 offset:19840
    s_cbranch_vccz gate_s_22
    s_bitcmp1_b32 s18, 0
    s_cbranch_scc1 gate_s_22_1
    v_mfma_f32_16x16x32_bf16 v[188:191], v[96:99], v[84:87], v[188:191]
    s_branch gate_s_22
gate_s_22_1:
    v_mfma_f32_16x16x32_bf16 v[192:195], v[96:99], v[88:91], v[192:195]
gate_s_22:
    v_add_u32 v6, s35, v6
    s_barrier
    ds_read_b128 v[76:79], v24 offset:0
    ds_read_b128 v[80:83], v24 offset:2048
    ds_read_b128 v[92:95], v28 offset:0
    s_waitcnt lgkmcnt(11)
    v_mfma_f32_16x16x32_bf16 v[124:127], v[56:59], v[84:87], v[124:127]
    ds_read_b64_tr_b16 v[32:33], v6 offset:0
    v_mfma_f32_16x16x32_bf16 v[168:171], v[56:59], v[88:91], v[168:171]
    ds_read_b64_tr_b16 v[34:35], v6 offset:1792
    s_waitcnt lgkmcnt(11)
    v_mfma_f32_16x16x32_bf16 v[128:131], v[60:63], v[84:87], v[128:131]
    ds_read_b64_tr_b16 v[36:37], v6 offset:32
    v_mfma_f32_16x16x32_bf16 v[172:175], v[60:63], v[88:91], v[172:175]
    ds_read_b64_tr_b16 v[38:39], v6 offset:1824
    s_waitcnt lgkmcnt(11)
    v_mfma_f32_16x16x32_bf16 v[132:135], v[64:67], v[84:87], v[132:135]
    ds_read_b64_tr_b16 v[40:41], v6 offset:64
    v_mfma_f32_16x16x32_bf16 v[176:179], v[64:67], v[88:91], v[176:179]
    ds_read_b64_tr_b16 v[42:43], v6 offset:1856
    s_waitcnt lgkmcnt(11)
    v_mfma_f32_16x16x32_bf16 v[136:139], v[68:71], v[84:87], v[136:139]
    ds_read_b64_tr_b16 v[44:45], v7 offset:0
    v_mfma_f32_16x16x32_bf16 v[180:183], v[68:71], v[88:91], v[180:183]
    ds_read_b64_tr_b16 v[46:47], v7 offset:1792
    s_waitcnt lgkmcnt(11)
    v_mfma_f32_16x16x32_bf16 v[140:143], v[72:75], v[84:87], v[140:143]
    ds_read_b64_tr_b16 v[48:49], v6 offset:7200
    v_mfma_f32_16x16x32_bf16 v[184:187], v[72:75], v[88:91], v[184:187]
    ds_read_b64_tr_b16 v[50:51], v6 offset:8992
    s_add_u32 s36, s36, 1
    s_cmp_lt_u32 s36, 6
    s_cbranch_scc1 P1_loop_20
    s_waitcnt vmcnt(0)
    v_readfirstlane_b32 s3, v29
    s_cmp_lg_u32 s3, 0
    s_cbranch_scc1 tag_23_done
    s_mov_b32 s62, 0
tag_23:
    v_mov_b32 v29, 0
    global_load_dword v29, v29, s[80:81] sc1
    s_waitcnt vmcnt(0)
    v_readfirstlane_b32 s3, v29
    s_add_u32 s62, s62, 1
    s_cmp_gt_u32 s62, 65536
    s_cbranch_scc1 tag_23_done
    s_cmp_eq_u32 s3, 0
    s_cbranch_scc1 tag_23

tag_23_done:
    v_mov_b32 v222, v2
    v_mov_b32 v223, s3
    v_mov_b32 v224, v3
    v_mov_b32 v225, s3
    v_mov_b32 v226, v4
    v_mov_b32 v227, s3
    s_waitcnt lgkmcnt(8)
    v_mfma_f32_16x16x32_bf16 v[100:103], v[32:35], v[76:79], v[100:103]
    ds_read_b64_tr_b16 v[52:53], v6 offset:7232
    v_mfma_f32_16x16x32_bf16 v[144:147], v[32:35], v[80:83], v[144:147]
    ds_read_b64_tr_b16 v[54:55], v6 offset:9024
    s_waitcnt lgkmcnt(8)
    v_mfma_f32_16x16x32_bf16 v[104:107], v[36:39], v[76:79], v[104:107]
    ds_read_b64_tr_b16 v[56:57], v6 offset:7264
    v_mfma_f32_16x16x32_bf16 v[148:151], v[36:39], v[80:83], v[148:151]
    ds_read_b64_tr_b16 v[58:59], v6 offset:9056
    s_waitcnt lgkmcnt(8)
    v_mfma_f32_16x16x32_bf16 v[108:111], v[40:43], v[76:79], v[108:111]
    ds_read_b64_tr_b16 v[60:61], v6 offset:14368
    v_mfma_f32_16x16x32_bf16 v[152:155], v[40:43], v[80:83], v[152:155]
    ds_read_b64_tr_b16 v[62:63], v6 offset:16160
    s_waitcnt lgkmcnt(8)
    v_mfma_f32_16x16x32_bf16 v[112:115], v[44:47], v[76:79], v[112:115]
    ds_read_b64_tr_b16 v[64:65], v6 offset:14400
    v_mfma_f32_16x16x32_bf16 v[156:159], v[44:47], v[80:83], v[156:159]
    ds_read_b64_tr_b16 v[66:67], v6 offset:16192
    s_waitcnt lgkmcnt(8)
    v_mfma_f32_16x16x32_bf16 v[116:119], v[48:51], v[76:79], v[116:119]
    ds_read_b64_tr_b16 v[68:69], v6 offset:14432
    v_mfma_f32_16x16x32_bf16 v[160:163], v[48:51], v[80:83], v[160:163]
    ds_read_b64_tr_b16 v[70:71], v6 offset:16224
    s_waitcnt lgkmcnt(8)
    v_mfma_f32_16x16x32_bf16 v[120:123], v[52:55], v[76:79], v[120:123]
    ds_read_b64_tr_b16 v[72:73], v6 offset:14464
    v_mfma_f32_16x16x32_bf16 v[164:167], v[52:55], v[80:83], v[164:167]
    ds_read_b64_tr_b16 v[74:75], v6 offset:16256
    s_cbranch_vccz gate_s_24
    s_bitcmp1_b32 s18, 0
    s_cbranch_scc1 gate_s_24_1
    v_mfma_f32_16x16x32_bf16 v[188:191], v[92:95], v[76:79], v[188:191]
    s_branch gate_s_24
gate_s_24_1:
    v_mfma_f32_16x16x32_bf16 v[192:195], v[92:95], v[80:83], v[192:195]
gate_s_24:
    ds_read_b128 v[84:87], v25 offset:0
    ds_read_b128 v[88:91], v25 offset:2048
    ds_read_b128 v[96:99], v28 offset:64
    s_waitcnt lgkmcnt(11)
    v_mfma_f32_16x16x32_bf16 v[124:127], v[56:59], v[76:79], v[124:127]
    ds_read_b64_tr_b16 v[32:33], v6 offset:3584
    v_mfma_f32_16x16x32_bf16 v[168:171], v[56:59], v[80:83], v[168:171]
    ds_read_b64_tr_b16 v[34:35], v6 offset:5376
    s_waitcnt lgkmcnt(11)
    v_mfma_f32_16x16x32_bf16 v[128:131], v[60:63], v[76:79], v[128:131]
    ds_read_b64_tr_b16 v[36:37], v6 offset:3616
    v_mfma_f32_16x16x32_bf16 v[172:175], v[60:63], v[80:83], v[172:175]
    ds_read_b64_tr_b16 v[38:39], v6 offset:5408
    s_waitcnt lgkmcnt(11)
    v_mfma_f32_16x16x32_bf16 v[132:135], v[64:67], v[76:79], v[132:135]
    ds_read_b64_tr_b16 v[40:41], v6 offset:3648
    v_mfma_f32_16x16x32_bf16 v[176:179], v[64:67], v[80:83], v[176:179]
    ds_read_b64_tr_b16 v[42:43], v6 offset:5440
    s_waitcnt lgkmcnt(11)
    v_mfma_f32_16x16x32_bf16 v[136:139], v[68:71], v[76:79], v[136:139]
    ds_read_b64_tr_b16 v[44:45], v7 offset:3584
    v_mfma_f32_16x16x32_bf16 v[180:183], v[68:71], v[80:83], v[180:183]
    ds_read_b64_tr_b16 v[46:47], v7 offset:5376
    s_waitcnt lgkmcnt(11)
    v_mfma_f32_16x16x32_bf16 v[140:143], v[72:75], v[76:79], v[140:143]
    ds_read_b64_tr_b16 v[48:49], v6 offset:10784
    v_mfma_f32_16x16x32_bf16 v[184:187], v[72:75], v[80:83], v[184:187]
    ds_read_b64_tr_b16 v[50:51], v6 offset:12576
    ds_write_b64 v23, v[222:223] offset:0
    ds_write_b64 v23, v[224:225] offset:16384
    ds_write_b64 v23, v[226:227] offset:32768
    s_waitcnt lgkmcnt(11)
    v_mfma_f32_16x16x32_bf16 v[100:103], v[32:35], v[84:87], v[100:103]
    ds_read_b64_tr_b16 v[52:53], v6 offset:10816
    v_mfma_f32_16x16x32_bf16 v[144:147], v[32:35], v[88:91], v[144:147]
    ds_read_b64_tr_b16 v[54:55], v6 offset:12608
    s_waitcnt lgkmcnt(11)
    v_mfma_f32_16x16x32_bf16 v[104:107], v[36:39], v[84:87], v[104:107]
    ds_read_b64_tr_b16 v[56:57], v6 offset:10848
    v_mfma_f32_16x16x32_bf16 v[148:151], v[36:39], v[88:91], v[148:151]
    ds_read_b64_tr_b16 v[58:59], v6 offset:12640
    s_waitcnt lgkmcnt(11)
    v_mfma_f32_16x16x32_bf16 v[108:111], v[40:43], v[84:87], v[108:111]
    ds_read_b64_tr_b16 v[60:61], v6 offset:17952
    v_mfma_f32_16x16x32_bf16 v[152:155], v[40:43], v[88:91], v[152:155]
    ds_read_b64_tr_b16 v[62:63], v6 offset:19744
    s_waitcnt lgkmcnt(11)
    v_mfma_f32_16x16x32_bf16 v[112:115], v[44:47], v[84:87], v[112:115]
    ds_read_b64_tr_b16 v[64:65], v6 offset:17984
    v_mfma_f32_16x16x32_bf16 v[156:159], v[44:47], v[88:91], v[156:159]
    ds_read_b64_tr_b16 v[66:67], v6 offset:19776
    v_cvt_pk_bf16_f32 v100, v100, v101
    v_cvt_pk_bf16_f32 v101, v102, v103
    v_cvt_pk_bf16_f32 v144, v144, v145
    v_cvt_pk_bf16_f32 v145, v146, v147
    ds_write_b64 v12, v[100:101] offset:0
    ds_write_b64 v12, v[144:145] offset:1024
    s_waitcnt lgkmcnt(13)
    v_mfma_f32_16x16x32_bf16 v[116:119], v[48:51], v[84:87], v[116:119]
    ds_read_b64_tr_b16 v[68:69], v6 offset:18016
    v_mfma_f32_16x16x32_bf16 v[160:163], v[48:51], v[88:91], v[160:163]
    ds_read_b64_tr_b16 v[70:71], v6 offset:19808
    v_cvt_pk_bf16_f32 v104, v104, v105
    v_cvt_pk_bf16_f32 v105, v106, v107
    v_cvt_pk_bf16_f32 v148, v148, v149
    v_cvt_pk_bf16_f32 v149, v150, v151
    ds_write_b64 v13, v[104:105] offset:0
    ds_write_b64 v13, v[148:149] offset:1024
    s_waitcnt lgkmcnt(12)
    v_mfma_f32_16x16x32_bf16 v[120:123], v[52:55], v[84:87], v[120:123]
    ds_read_b64_tr_b16 v[72:73], v6 offset:18048
    v_mfma_f32_16x16x32_bf16 v[164:167], v[52:55], v[88:91], v[164:167]
    ds_read_b64_tr_b16 v[74:75], v6 offset:19840
    s_cbranch_vccz gate_s_25
    s_bitcmp1_b32 s18, 0
    s_cbranch_scc1 gate_s_25_1
    v_mfma_f32_16x16x32_bf16 v[188:191], v[96:99], v[84:87], v[188:191]
    s_branch gate_s_25
gate_s_25_1:
    v_mfma_f32_16x16x32_bf16 v[192:195], v[96:99], v[88:91], v[192:195]
gate_s_25:
    v_cvt_pk_bf16_f32 v108, v108, v109
    v_cvt_pk_bf16_f32 v109, v110, v111
    v_cvt_pk_bf16_f32 v152, v152, v153
    v_cvt_pk_bf16_f32 v153, v154, v155
    ds_write_b64 v14, v[108:109] offset:0
    ds_write_b64 v14, v[152:153] offset:1024
    s_waitcnt lgkmcnt(14)
    v_mfma_f32_16x16x32_bf16 v[124:127], v[56:59], v[84:87], v[124:127]
    v_mfma_f32_16x16x32_bf16 v[168:171], v[56:59], v[88:91], v[168:171]
    v_cvt_pk_bf16_f32 v112, v112, v113
    v_cvt_pk_bf16_f32 v113, v114, v115
    v_cvt_pk_bf16_f32 v156, v156, v157
    v_cvt_pk_bf16_f32 v157, v158, v159
    ds_write_b64 v15, v[112:113] offset:0
    ds_write_b64 v15, v[156:157] offset:1024
    s_waitcnt lgkmcnt(14)
    v_mfma_f32_16x16x32_bf16 v[128:131], v[60:63], v[84:87], v[128:131]
    v_mfma_f32_16x16x32_bf16 v[172:175], v[60:63], v[88:91], v[172:175]
    v_cvt_pk_bf16_f32 v116, v116, v117
    v_cvt_pk_bf16_f32 v117, v118, v119
    v_cvt_pk_bf16_f32 v160, v160, v161
    v_cvt_pk_bf16_f32 v161, v162, v163
    ds_write_b64 v16, v[116:117] offset:0
    ds_write_b64 v16, v[160:161] offset:1024
    s_waitcnt lgkmcnt(14)
    v_mfma_f32_16x16x32_bf16 v[132:135], v[64:67], v[84:87], v[132:135]
    v_mfma_f32_16x16x32_bf16 v[176:179], v[64:67], v[88:91], v[176:179]
    v_cvt_pk_bf16_f32 v120, v120, v121
    v_cvt_pk_bf16_f32 v121, v122, v123
    v_cvt_pk_bf16_f32 v164, v164, v165
    v_cvt_pk_bf16_f32 v165, v166, v167
    ds_write_b64 v17, v[120:121] offset:0
    ds_write_b64 v17, v[164:165] offset:1024
    s_waitcnt lgkmcnt(12)
    v_mfma_f32_16x16x32_bf16 v[136:139], v[68:71], v[84:87], v[136:139]
    v_mfma_f32_16x16x32_bf16 v[180:183], v[68:71], v[88:91], v[180:183]
    v_cvt_pk_bf16_f32 v124, v124, v125
    v_cvt_pk_bf16_f32 v125, v126, v127
    v_cvt_pk_bf16_f32 v168, v168, v169
    v_cvt_pk_bf16_f32 v169, v170, v171
    ds_write_b64 v18, v[124:125] offset:0
    ds_write_b64 v18, v[168:169] offset:1024
    s_waitcnt lgkmcnt(10)
    v_mfma_f32_16x16x32_bf16 v[140:143], v[72:75], v[84:87], v[140:143]
    v_mfma_f32_16x16x32_bf16 v[184:187], v[72:75], v[88:91], v[184:187]
    v_cvt_pk_bf16_f32 v128, v128, v129
    v_cvt_pk_bf16_f32 v129, v130, v131
    v_cvt_pk_bf16_f32 v172, v172, v173
    v_cvt_pk_bf16_f32 v173, v174, v175
    ds_write_b64 v19, v[128:129] offset:0
    ds_write_b64 v19, v[172:173] offset:1024
    v_cvt_pk_bf16_f32 v132, v132, v133
    v_cvt_pk_bf16_f32 v133, v134, v135
    v_cvt_pk_bf16_f32 v176, v176, v177
    v_cvt_pk_bf16_f32 v177, v178, v179
    ds_write_b64 v20, v[132:133] offset:0
    ds_write_b64 v20, v[176:177] offset:1024
    v_cvt_pk_bf16_f32 v136, v136, v137
    v_cvt_pk_bf16_f32 v137, v138, v139
    v_cvt_pk_bf16_f32 v180, v180, v181
    v_cvt_pk_bf16_f32 v181, v182, v183
    ds_write_b64 v21, v[136:137] offset:0
    ds_write_b64 v21, v[180:181] offset:1024
    v_cvt_pk_bf16_f32 v140, v140, v141
    v_cvt_pk_bf16_f32 v141, v142, v143
    v_cvt_pk_bf16_f32 v184, v184, v185
    v_cvt_pk_bf16_f32 v185, v186, v187
    ds_write_b64 v22, v[140:141] offset:0
    ds_write_b64 v22, v[184:185] offset:1024
    s_waitcnt lgkmcnt(0)
    s_barrier
    s_mov_b32 s12, s82
    s_mov_b32 s13, s83
    s_mov_b32 s14, 10633216
    s_mov_b32 s15, 0x20000
    s_cmp_ge_u32 s18, 6
    s_cbranch_scc1 vskip_26
    v_lshlrev_b32 v8, 4, v1
    s_lshl_b32 s23, s56, 10
    v_add_u32 v8, s23, v8
    s_mul_i32 s24, s18, 786432
    s_lshl_b32 s25, s17, 13
    s_add_u32 s24, s24, s25

    ds_read_b128 v[100:103], v8 offset:0
    ds_read_b128 v[104:107], v8 offset:8192
    ds_read_b128 v[108:111], v8 offset:16384
    ds_read_b128 v[112:115], v8 offset:24576
    ds_read_b128 v[116:119], v8 offset:32768
    ds_read_b128 v[120:123], v8 offset:40960
    s_waitcnt lgkmcnt(5)
    s_add_u32 s25, s24, 0
    buffer_store_dwordx4 v[100:103], v8, s[12:15], s25 offen sc1
    s_waitcnt lgkmcnt(4)
    s_add_u32 s25, s24, 131072
    buffer_store_dwordx4 v[104:107], v8, s[12:15], s25 offen sc1
    s_waitcnt lgkmcnt(3)
    s_add_u32 s25, s24, 262144
    buffer_store_dwordx4 v[108:111], v8, s[12:15], s25 offen sc1
    s_waitcnt lgkmcnt(2)
    s_add_u32 s25, s24, 393216
    buffer_store_dwordx4 v[112:115], v8, s[12:15], s25 offen sc1
    s_waitcnt lgkmcnt(1)
    s_add_u32 s25, s24, 524288
    buffer_store_dwordx4 v[116:119], v8, s[12:15], s25 offen sc1
    s_waitcnt lgkmcnt(0)
    s_add_u32 s25, s24, 655360
    buffer_store_dwordx4 v[120:123], v8, s[12:15], s25 offen sc1
vskip_26:
    s_lshr_b32 s23, s18, 1
    s_cmp_lg_u32 s23, s56
    s_cbranch_scc1 gate_skip_27
    s_bitcmp1_b32 s18, 0
    s_cselect_b64 vcc, -1, 0
    s_nop 4
    v_cndmask_b32 v8, v188, v192, vcc
    v_mul_f32 v8, 3216550459, v8
    v_exp_f32 v8, v8
    s_nop 0
    v_add_f32 v8, 1.0, v8
    v_rcp_f32 v220, v8
    v_mov_b32 v221, s3
    s_lshl_b32 s23, s17, 7
    s_lshl_b32 s24, s18, 4
    s_add_u32 s23, s23, s24
    s_lshl_b32 s23, s23, 3
    s_add_u32 s23, s23, 10485760
    v_lshlrev_b32 v9, 3, v1
    s_mov_b64 exec, 0xffff
    buffer_store_dwordx2 v[220:221], v9, s[12:15], s23 offen sc1
    s_mov_b64 exec, -1

gate_skip_27:
    s_branch P2_START
P1_B:
    v_lshrrev_b32 v8, 4, v1
    v_and_b32 v9, 1, v8
    v_lshlrev_b32 v9, 3, v9
    v_lshrrev_b32 v10, 1, v8
    v_add_u32 v9, v9, v10
    v_bfe_u32 v10, v1, 2, 2
    v_lshlrev_b32 v10, 1, v10
    v_add_u32 v9, v9, v10
    v_mul_u32_u24 v9, 112, v9
    v_and_b32 v10, 3, v1
    v_lshlrev_b32 v11, 3, v10
    v_add_u32 v6, v9, v11
    v_add_u32 v7, 96, v6
    v_add_u32 v11, 7168, v6
    v_cmp_lt_u32 vcc, 1, v10
    v_and_b32 v9, 15, v1
    v_lshrrev_b32 v10, 1, v9
    v_cndmask_b32 v7, v7, v11, vcc
    v_xor_b32 v10, v10, v8
    v_lshlrev_b32 v10, 4, v10
    v_lshlrev_b32 v9, 7, v9
    v_add_u32 v26, v9, v10
    v_add_u32 v26, 21552, v26
    v_xor_b32 v10, 64, v10
    v_add_u32 v27, v9, v10
    v_add_u32 v27, 21552, v27
    s_lshl_b32 s23, s56, 12
    s_add_u32 s23, s23, 2048
    v_add_u32 v24, s23, v26
    v_add_u32 v25, s23, v27
    v_lshlrev_b32 v28, 4, v8

    v_and_b32 v8, 15, v1
    s_lshl_b32 s23, s56, 5
    v_add_u32 v9, s23, v8
    v_lshlrev_b32 v23, 6, v9
    v_add_u32 v23, 49152, v23
    v_lshrrev_b32 v8, 2, v8

    v_and_b32 v9, 1, v8
    v_lshlrev_b32 v9, 1, v9
    v_lshrrev_b32 v10, 1, v8
    v_mul_u32_u24 v10, 3, v10
    v_xor_b32 v9, v9, v10

    v_lshrrev_b32 v8, 4, v1
    v_add_u32 v10, 0, v8
    v_mul_u32_u24 v11, 37, v10
    v_lshrrev_b32 v11, 8, v11
    v_mul_u32_u24 v12, 7, v11
    v_sub_u32 v10, v10, v12
    v_mul_u32_u24 v11, 9216, v11
    v_add_u32 v11, v11, v23
    v_lshrrev_b32 v12, 1, v10
    v_xor_b32 v12, v12, v9
    v_lshl_add_u32 v12, v12, 4, v11
    v_and_b32 v10, 1, v10
    v_lshl_add_u32 v12, v10, 3, v12

    v_add_u32 v10, 4, v8
    v_mul_u32_u24 v11, 37, v10
    v_lshrrev_b32 v11, 8, v11
    v_mul_u32_u24 v13, 7, v11
    v_sub_u32 v10, v10, v13
    v_mul_u32_u24 v11, 9216, v11
    v_add_u32 v11, v11, v23
    v_lshrrev_b32 v13, 1, v10
    v_xor_b32 v13, v13, v9
    v_lshl_add_u32 v13, v13, 4, v11
    v_and_b32 v10, 1, v10
    v_lshl_add_u32 v13, v10, 3, v13

    v_add_u32 v10, 8, v8
    v_mul_u32_u24 v11, 37, v10
    v_lshrrev_b32 v11, 8, v11
    v_mul_u32_u24 v14, 7, v11
    v_sub_u32 v10, v10, v14
    v_mul_u32_u24 v11, 9216, v11
    v_add_u32 v11, v11, v23
    v_lshrrev_b32 v14, 1, v10
    v_xor_b32 v14, v14, v9
    v_lshl_add_u32 v14, v14, 4, v11
    v_and_b32 v10, 1, v10
    v_lshl_add_u32 v14, v10, 3, v14

    v_add_u32 v10, 12, v8
    v_mul_u32_u24 v11, 37, v10
    v_lshrrev_b32 v11, 8, v11
    v_mul_u32_u24 v15, 7, v11
    v_sub_u32 v10, v10, v15
    v_mul_u32_u24 v11, 9216, v11
    v_add_u32 v11, v11, v23
    v_lshrrev_b32 v15, 1, v10
    v_xor_b32 v15, v15, v9
    v_lshl_add_u32 v15, v15, 4, v11
    v_and_b32 v10, 1, v10
    v_lshl_add_u32 v15, v10, 3, v15

    v_add_u32 v10, 16, v8
    v_mul_u32_u24 v11, 37, v10
    v_lshrrev_b32 v11, 8, v11
    v_mul_u32_u24 v16, 7, v11
    v_sub_u32 v10, v10, v16
    v_mul_u32_u24 v11, 9216, v11
    v_add_u32 v11, v11, v23
    v_lshrrev_b32 v16, 1, v10
    v_xor_b32 v16, v16, v9
    v_lshl_add_u32 v16, v16, 4, v11
    v_and_b32 v10, 1, v10
    v_lshl_add_u32 v16, v10, 3, v16

    v_add_u32 v10, 20, v8
    v_mul_u32_u24 v11, 37, v10
    v_lshrrev_b32 v11, 8, v11
    v_mul_u32_u24 v17, 7, v11
    v_sub_u32 v10, v10, v17
    v_mul_u32_u24 v11, 9216, v11
    v_add_u32 v11, v11, v23
    v_lshrrev_b32 v17, 1, v10
    v_xor_b32 v17, v17, v9
    v_lshl_add_u32 v17, v17, 4, v11
    v_and_b32 v10, 1, v10
    v_lshl_add_u32 v17, v10, 3, v17

    v_add_u32 v10, 24, v8
    v_mul_u32_u24 v11, 37, v10
    v_lshrrev_b32 v11, 8, v11
    v_mul_u32_u24 v18, 7, v11
    v_sub_u32 v10, v10, v18
    v_mul_u32_u24 v11, 9216, v11
    v_add_u32 v11, v11, v23
    v_lshrrev_b32 v18, 1, v10
    v_xor_b32 v18, v18, v9
    v_lshl_add_u32 v18, v18, 4, v11
    v_and_b32 v10, 1, v10
    v_lshl_add_u32 v18, v10, 3, v18

    v_add_u32 v10, 28, v8
    v_mul_u32_u24 v11, 37, v10
    v_lshrrev_b32 v11, 8, v11
    v_mul_u32_u24 v19, 7, v11
    v_sub_u32 v10, v10, v19
    v_mul_u32_u24 v11, 9216, v11
    v_add_u32 v11, v11, v23
    v_lshrrev_b32 v19, 1, v10
    v_xor_b32 v19, v19, v9
    v_lshl_add_u32 v19, v19, 4, v11
    v_and_b32 v10, 1, v10
    v_lshl_add_u32 v19, v10, 3, v19

    v_add_u32 v10, 32, v8
    v_mul_u32_u24 v11, 37, v10
    v_lshrrev_b32 v11, 8, v11
    v_mul_u32_u24 v20, 7, v11
    v_sub_u32 v10, v10, v20
    v_mul_u32_u24 v11, 9216, v11
    v_add_u32 v11, v11, v23
    v_lshrrev_b32 v20, 1, v10
    v_xor_b32 v20, v20, v9
    v_lshl_add_u32 v20, v20, 4, v11
    v_and_b32 v10, 1, v10
    v_lshl_add_u32 v20, v10, 3, v20

    v_add_u32 v10, 36, v8
    v_mul_u32_u24 v11, 37, v10
    v_lshrrev_b32 v11, 8, v11
    v_mul_u32_u24 v21, 7, v11
    v_sub_u32 v10, v10, v21
    v_mul_u32_u24 v11, 9216, v11
    v_add_u32 v11, v11, v23
    v_lshrrev_b32 v21, 1, v10
    v_xor_b32 v21, v21, v9
    v_lshl_add_u32 v21, v21, 4, v11
    v_and_b32 v10, 1, v10
    v_lshl_add_u32 v21, v10, 3, v21

    v_add_u32 v10, 40, v8
    v_mul_u32_u24 v11, 37, v10
    v_lshrrev_b32 v11, 8, v11
    v_mul_u32_u24 v22, 7, v11
    v_sub_u32 v10, v10, v22
    v_mul_u32_u24 v11, 9216, v11
    v_add_u32 v11, v11, v23
    v_lshrrev_b32 v22, 1, v10
    v_xor_b32 v22, v22, v9
    v_lshl_add_u32 v22, v22, 4, v11
    v_and_b32 v10, 1, v10
    v_lshl_add_u32 v22, v10, 3, v22

    v_and_b32 v8, 31, v1
    v_bfe_u32 v9, v1, 2, 2

    v_and_b32 v10, 1, v9
    v_lshlrev_b32 v10, 1, v10
    v_lshrrev_b32 v11, 1, v9
    v_mul_u32_u24 v11, 3, v11
    v_xor_b32 v10, v10, v11

    v_xor_b32 v10, 3, v10
    v_lshlrev_b32 v10, 4, v10
    s_lshl_b32 s23, s56, 5
    v_add_u32 v8, s23, v8
    v_lshl_add_u32 v10, v8, 6, v10
    v_lshrrev_b32 v9, 5, v1
    v_mul_u32_u24 v11, 9216, v9
    v_add_u32 v23, v10, v11
    v_add_u32 v23, 50184, v23

    v_mov_b32 v222, 0x3f80
    v_mov_b32 v223, 0
    v_mov_b32 v224, 0
    v_mov_b32 v225, 0
    v_and_b32 v8, 15, v1
    v_lshrrev_b32 v9, 2, v8

    v_and_b32 v10, 1, v9
    v_lshlrev_b32 v10, 1, v10
    v_lshrrev_b32 v11, 1, v9
    v_mul_u32_u24 v11, 3, v11
    v_xor_b32 v10, v10, v11

    v_xor_b32 v10, 3, v10
    v_lshlrev_b32 v10, 4, v10
    v_lshl_add_u32 v10, v8, 6, v10
    v_lshrrev_b32 v9, 4, v1
    v_add_u32 v9, 2, v9
    v_mul_u32_u24 v11, 9216, v9
    v_add3_u32 v10, v10, v11, 8
    v_add_u32 v226, 49152, v10
    v_cmp_lt_u32 vcc, 3, v9
    v_mov_b32 v229, 0
    s_nop 0
    v_cndmask_b32 v228, 0, v222, vcc

    v_and_b32 v8, 15, v1
    v_lshrrev_b32 v9, 2, v8
    v_and_b32 v10, 1, v9
    v_lshlrev_b32 v10, 1, v10
    v_lshrrev_b32 v11, 1, v9
    v_mul_u32_u24 v11, 3, v11
    v_xor_b32 v10, v10, v11

    v_lshrrev_b32 v9, 4, v1
    v_xor_b32 v11, v10, v9
    v_lshlrev_b32 v11, 4, v11
    s_lshl_b32 s23, s56, 5
    v_add_u32 v230, s23, v8
    v_lshl_add_u32 v230, v230, 6, v11
    v_add_u32 v230, 49152, v230
    v_lshrrev_b32 v11, 1, v9
    v_xor_b32 v11, v11, v10
    v_lshlrev_b32 v11, 4, v11
    v_lshl_add_u32 v233, v8, 6, v11
    v_and_b32 v11, 1, v9
    v_lshl_add_u32 v233, v11, 3, v233
    s_lshl_b32 s23, s56, 12
    s_add_u32 s23, s23, 123904
    v_add_u32 v233, s23, v233
    v_xor_b32 v234, 32, v233
    v_lshlrev_b32 v235, 4, v1
    v_add_u32 v235, s23, v235

    v_and_b32 v10, 1, v9
    v_lshlrev_b32 v10, 1, v10
    v_lshrrev_b32 v11, 1, v9
    v_mul_u32_u24 v11, 3, v11
    v_xor_b32 v10, v10, v11

    v_bfe_u32 v11, v1, 1, 1
    v_xor_b32 v10, v10, v11
    v_lshlrev_b32 v10, 4, v10
    v_and_b32 v11, 1, v1
    v_lshl_add_u32 v10, v11, 3, v10
    v_lshlrev_b32 v11, 2, v9
    v_bfe_u32 v231, v1, 2, 2
    v_add_u32 v11, v11, v231
    s_lshl_b32 s23, s56, 5
    v_add_u32 v11, s23, v11
    v_lshl_add_u32 v231, v11, 6, v10
    v_add_u32 v231, 49152, v231
    v_xor_b32 v232, 32, v231
    v_and_b32 v8, 15, v1
    v_lshlrev_b32 v10, 2, v9
    v_sub_u32 v8, v8, v10
    v_mov_b32 v11, 4286578688

    v_subrev_u32 v10, 0, v8
    v_and_b32 v9, 0xfffffff1, v10
    v_cmp_eq_u32 vcc, 0, v9
    v_add_u32 v10, 16, v10
    v_and_b32 v9, 0xfffffff1, v10
    v_cndmask_b32 v240, v11, 0, vcc
    v_cmp_eq_u32 vcc, 0, v9
    s_nop 1
    v_cndmask_b32 v236, v11, 0, vcc
    v_mov_b32 v244, v236

    v_subrev_u32 v10, 1, v8
    v_and_b32 v9, 0xfffffff1, v10
    v_cmp_eq_u32 vcc, 0, v9
    v_add_u32 v10, 16, v10
    v_and_b32 v9, 0xfffffff1, v10
    v_cndmask_b32 v241, v11, 0, vcc
    v_cmp_eq_u32 vcc, 0, v9
    s_nop 1
    v_cndmask_b32 v237, v11, 0, vcc
    v_mov_b32 v245, v237

    v_subrev_u32 v10, 2, v8
    v_and_b32 v9, 0xfffffff1, v10
    v_cmp_eq_u32 vcc, 0, v9
    v_add_u32 v10, 16, v10
    v_and_b32 v9, 0xfffffff1, v10
    v_cndmask_b32 v242, v11, 0, vcc
    v_cmp_eq_u32 vcc, 0, v9
    s_nop 1
    v_cndmask_b32 v238, v11, 0, vcc
    v_mov_b32 v246, v238

    v_subrev_u32 v10, 3, v8
    v_and_b32 v9, 0xfffffff1, v10
    v_cmp_eq_u32 vcc, 0, v9
    v_add_u32 v10, 16, v10
    v_and_b32 v9, 0xfffffff1, v10
    v_cndmask_b32 v243, v11, 0, vcc
    v_cmp_eq_u32 vcc, 0, v9
    s_nop 1
    v_cndmask_b32 v239, v11, 0, vcc
    v_mov_b32 v247, v239

    s_or_b32 s23, s17, s56
    s_cmp_lg_u32 s23, 0
    s_cbranch_scc1 B_m0_28
    v_mov_b32 v244, v11
    v_mov_b32 v245, v11
    v_mov_b32 v246, v11
    v_mov_b32 v247, v11
B_m0_28:
    v_mov_b32 v100, 0
    v_mov_b32 v101, 0
    v_mov_b32 v102, 0
    v_mov_b32 v103, 0
    v_mov_b32 v104, 0
    v_mov_b32 v105, 0
    v_mov_b32 v106, 0
    v_mov_b32 v107, 0
    v_mov_b32 v108, 0
    v_mov_b32 v109, 0
    v_mov_b32 v110, 0
    v_mov_b32 v111, 0
    v_mov_b32 v112, 0
    v_mov_b32 v113, 0
    v_mov_b32 v114, 0
    v_mov_b32 v115, 0
    v_mov_b32 v116, 0
    v_mov_b32 v117, 0
    v_mov_b32 v118, 0
    v_mov_b32 v119, 0
    v_mov_b32 v120, 0
    v_mov_b32 v121, 0
    v_mov_b32 v122, 0
    v_mov_b32 v123, 0
    v_mov_b32 v124, 0
    v_mov_b32 v125, 0
    v_mov_b32 v126, 0
    v_mov_b32 v127, 0
    v_mov_b32 v128, 0
    v_mov_b32 v129, 0
    v_mov_b32 v130, 0
    v_mov_b32 v131, 0
    v_mov_b32 v132, 0
    v_mov_b32 v133, 0
    v_mov_b32 v134, 0
    v_mov_b32 v135, 0
    v_mov_b32 v136, 0
    v_mov_b32 v137, 0
    v_mov_b32 v138, 0
    v_mov_b32 v139, 0
    v_mov_b32 v140, 0
    v_mov_b32 v141, 0
    v_mov_b32 v142, 0
    v_mov_b32 v143, 0
    v_mov_b32 v144, 0
    v_mov_b32 v145, 0
    v_mov_b32 v146, 0
    v_mov_b32 v147, 0
    v_mov_b32 v148, 0
    v_mov_b32 v149, 0
    v_mov_b32 v150, 0
    v_mov_b32 v151, 0
    v_mov_b32 v152, 0
    v_mov_b32 v153, 0
    v_mov_b32 v154, 0
    v_mov_b32 v155, 0
    v_mov_b32 v156, 0
    v_mov_b32 v157, 0
    v_mov_b32 v158, 0
    v_mov_b32 v159, 0
    v_mov_b32 v160, 0
    v_mov_b32 v161, 0
    v_mov_b32 v162, 0
    v_mov_b32 v163, 0
    v_mov_b32 v164, 0
    v_mov_b32 v165, 0
    v_mov_b32 v166, 0
    v_mov_b32 v167, 0
    v_mov_b32 v168, 0
    v_mov_b32 v169, 0
    v_mov_b32 v170, 0
    v_mov_b32 v171, 0
    v_mov_b32 v172, 0
    v_mov_b32 v173, 0
    v_mov_b32 v174, 0
    v_mov_b32 v175, 0
    v_mov_b32 v176, 0
    v_mov_b32 v177, 0
    v_mov_b32 v178, 0
    v_mov_b32 v179, 0
    v_mov_b32 v180, 0
    v_mov_b32 v181, 0
    v_mov_b32 v182, 0
    v_mov_b32 v183, 0
    v_mov_b32 v184, 0
    v_mov_b32 v185, 0
    v_mov_b32 v186, 0
    v_mov_b32 v187, 0
    v_mov_b32 v188, 0
    v_mov_b32 v189, 0
    v_mov_b32 v190, 0
    v_mov_b32 v191, 0
    v_mov_b32 v192, 0
    v_mov_b32 v193, 0
    v_mov_b32 v194, 0
    v_mov_b32 v195, 0
    v_mov_b32 v196, 0
    v_mov_b32 v197, 0
    v_mov_b32 v198, 0
    v_mov_b32 v199, 0
    v_mov_b32 v200, 0
    v_mov_b32 v201, 0
    v_mov_b32 v202, 0
    v_mov_b32 v203, 0
    v_mov_b32 v204, 0
    v_mov_b32 v205, 0
    v_mov_b32 v206, 0
    v_mov_b32 v207, 0
    v_mov_b32 v208, 0
    v_mov_b32 v209, 0
    v_mov_b32 v210, 0
    v_mov_b32 v211, 0
    v_mov_b32 v212, 0
    v_mov_b32 v213, 0
    v_mov_b32 v214, 0
    v_mov_b32 v215, 0
    v_mov_b32 v216, 0
    v_mov_b32 v217, 0
    v_mov_b32 v218, 0
    v_mov_b32 v219, 0
    s_mov_b32 s34, 1
    s_mov_b32 s36, 0
    v_add_u32 v6, 39984, v6
    v_add_u32 v7, 39984, v7
    v_add_u32 v24, 39984, v24
    v_add_u32 v25, 39984, v25
    v_add_u32 v26, 39984, v26
    v_add_u32 v27, 39984, v27
    s_waitcnt lgkmcnt(0)
    s_barrier
    v_mov_b32 v29, 0
    global_load_dword v29, v29, s[80:81] sc1
    ds_read_b128 v[76:79], v24 offset:0
    ds_read_b128 v[80:83], v24 offset:2048
    ds_read_b128 v[92:95], v26
    ds_read_b64_tr_b16 v[32:33], v6 offset:0
    ds_read_b64_tr_b16 v[34:35], v6 offset:1792
    ds_read_b64_tr_b16 v[36:37], v6 offset:32
    ds_read_b64_tr_b16 v[38:39], v6 offset:1824
    ds_read_b64_tr_b16 v[40:41], v6 offset:64
    ds_read_b64_tr_b16 v[42:43], v6 offset:1856
    ds_read_b64_tr_b16 v[44:45], v7 offset:0
    ds_read_b64_tr_b16 v[46:47], v7 offset:1792
    ds_read_b64_tr_b16 v[48:49], v6 offset:7200
    ds_read_b64_tr_b16 v[50:51], v6 offset:8992
P1_loop_29:
    s_waitcnt lgkmcnt(8)
    v_mfma_f32_16x16x32_bf16 v[100:103], v[32:35], v[76:79], v[100:103]
    ds_read_b64_tr_b16 v[52:53], v6 offset:7232
    v_mfma_f32_16x16x32_bf16 v[144:147], v[32:35], v[80:83], v[144:147]
    ds_read_b64_tr_b16 v[54:55], v6 offset:9024
    s_waitcnt lgkmcnt(8)
    v_mfma_f32_16x16x32_bf16 v[104:107], v[36:39], v[76:79], v[104:107]
    ds_read_b64_tr_b16 v[56:57], v6 offset:7264
    v_mfma_f32_16x16x32_bf16 v[148:151], v[36:39], v[80:83], v[148:151]
    ds_read_b64_tr_b16 v[58:59], v6 offset:9056
    s_add_u32 s34, s34, 1
    s_and_b32 s34, s34, 3
    s_waitcnt lgkmcnt(8)
    v_mfma_f32_16x16x32_bf16 v[108:111], v[40:43], v[76:79], v[108:111]
    ds_read_b64_tr_b16 v[60:61], v6 offset:14368
    v_mfma_f32_16x16x32_bf16 v[152:155], v[40:43], v[80:83], v[152:155]
    ds_read_b64_tr_b16 v[62:63], v6 offset:16160
    s_cmp_eq_u32 s34, 0
    s_mov_b32 s35, 39984
    s_cselect_b32 s35, 0xfffe2b70, s35
    s_waitcnt lgkmcnt(8)
    v_mfma_f32_16x16x32_bf16 v[112:115], v[44:47], v[76:79], v[112:115]
    ds_read_b64_tr_b16 v[64:65], v6 offset:14400
    v_mfma_f32_16x16x32_bf16 v[156:159], v[44:47], v[80:83], v[156:159]
    ds_read_b64_tr_b16 v[66:67], v6 offset:16192
    v_mfma_f32_16x16x32_bf16 v[188:191], v[44:47], v[92:95], v[188:191]
    s_waitcnt lgkmcnt(8)
    v_mfma_f32_16x16x32_bf16 v[116:119], v[48:51], v[76:79], v[116:119]
    ds_read_b64_tr_b16 v[68:69], v6 offset:14432
    v_mfma_f32_16x16x32_bf16 v[160:163], v[48:51], v[80:83], v[160:163]
    ds_read_b64_tr_b16 v[70:71], v6 offset:16224
    v_mfma_f32_16x16x32_bf16 v[192:195], v[48:51], v[92:95], v[192:195]
    s_waitcnt lgkmcnt(8)
    v_mfma_f32_16x16x32_bf16 v[120:123], v[52:55], v[76:79], v[120:123]
    ds_read_b64_tr_b16 v[72:73], v6 offset:14464
    v_mfma_f32_16x16x32_bf16 v[164:167], v[52:55], v[80:83], v[164:167]
    ds_read_b64_tr_b16 v[74:75], v6 offset:16256
    v_mfma_f32_16x16x32_bf16 v[196:199], v[52:55], v[92:95], v[196:199]
    ds_read_b128 v[84:87], v25 offset:0
    ds_read_b128 v[88:91], v25 offset:2048
    ds_read_b128 v[96:99], v27
    s_waitcnt lgkmcnt(11)
    v_mfma_f32_16x16x32_bf16 v[124:127], v[56:59], v[76:79], v[124:127]
    ds_read_b64_tr_b16 v[32:33], v6 offset:3584
    v_mfma_f32_16x16x32_bf16 v[168:171], v[56:59], v[80:83], v[168:171]
    ds_read_b64_tr_b16 v[34:35], v6 offset:5376
    v_mfma_f32_16x16x32_bf16 v[200:203], v[56:59], v[92:95], v[200:203]
    s_waitcnt lgkmcnt(11)
    v_mfma_f32_16x16x32_bf16 v[128:131], v[60:63], v[76:79], v[128:131]
    ds_read_b64_tr_b16 v[36:37], v6 offset:3616
    v_mfma_f32_16x16x32_bf16 v[172:175], v[60:63], v[80:83], v[172:175]
    ds_read_b64_tr_b16 v[38:39], v6 offset:5408
    v_mfma_f32_16x16x32_bf16 v[204:207], v[60:63], v[92:95], v[204:207]
    v_add_u32 v24, s35, v24
    v_add_u32 v25, s35, v25
    s_waitcnt lgkmcnt(11)
    v_mfma_f32_16x16x32_bf16 v[132:135], v[64:67], v[76:79], v[132:135]
    ds_read_b64_tr_b16 v[40:41], v6 offset:3648
    v_mfma_f32_16x16x32_bf16 v[176:179], v[64:67], v[80:83], v[176:179]
    ds_read_b64_tr_b16 v[42:43], v6 offset:5440
    v_mfma_f32_16x16x32_bf16 v[208:211], v[64:67], v[92:95], v[208:211]
    v_add_u32 v26, s35, v26
    v_add_u32 v27, s35, v27
    s_waitcnt lgkmcnt(11)
    v_mfma_f32_16x16x32_bf16 v[136:139], v[68:71], v[76:79], v[136:139]
    ds_read_b64_tr_b16 v[44:45], v7 offset:3584
    v_mfma_f32_16x16x32_bf16 v[180:183], v[68:71], v[80:83], v[180:183]
    ds_read_b64_tr_b16 v[46:47], v7 offset:5376
    v_mfma_f32_16x16x32_bf16 v[212:215], v[68:71], v[92:95], v[212:215]
    s_waitcnt lgkmcnt(11)
    v_mfma_f32_16x16x32_bf16 v[140:143], v[72:75], v[76:79], v[140:143]
    ds_read_b64_tr_b16 v[48:49], v6 offset:10784
    v_mfma_f32_16x16x32_bf16 v[184:187], v[72:75], v[80:83], v[184:187]
    ds_read_b64_tr_b16 v[50:51], v6 offset:12576
    v_mfma_f32_16x16x32_bf16 v[216:219], v[72:75], v[92:95], v[216:219]
    v_add_u32 v7, s35, v7
    s_waitcnt lgkmcnt(8)
    v_mfma_f32_16x16x32_bf16 v[100:103], v[32:35], v[84:87], v[100:103]
    ds_read_b64_tr_b16 v[52:53], v6 offset:10816
    v_mfma_f32_16x16x32_bf16 v[144:147], v[32:35], v[88:91], v[144:147]
    ds_read_b64_tr_b16 v[54:55], v6 offset:12608
    s_waitcnt lgkmcnt(8)
    v_mfma_f32_16x16x32_bf16 v[104:107], v[36:39], v[84:87], v[104:107]
    ds_read_b64_tr_b16 v[56:57], v6 offset:10848
    v_mfma_f32_16x16x32_bf16 v[148:151], v[36:39], v[88:91], v[148:151]
    ds_read_b64_tr_b16 v[58:59], v6 offset:12640
    s_waitcnt lgkmcnt(8)
    v_mfma_f32_16x16x32_bf16 v[108:111], v[40:43], v[84:87], v[108:111]
    ds_read_b64_tr_b16 v[60:61], v6 offset:17952
    v_mfma_f32_16x16x32_bf16 v[152:155], v[40:43], v[88:91], v[152:155]
    ds_read_b64_tr_b16 v[62:63], v6 offset:19744
    s_waitcnt lgkmcnt(8)
    v_mfma_f32_16x16x32_bf16 v[112:115], v[44:47], v[84:87], v[112:115]
    ds_read_b64_tr_b16 v[64:65], v6 offset:17984
    v_mfma_f32_16x16x32_bf16 v[156:159], v[44:47], v[88:91], v[156:159]
    ds_read_b64_tr_b16 v[66:67], v6 offset:19776
    v_mfma_f32_16x16x32_bf16 v[188:191], v[44:47], v[96:99], v[188:191]
    s_waitcnt lgkmcnt(8)
    v_mfma_f32_16x16x32_bf16 v[116:119], v[48:51], v[84:87], v[116:119]
    ds_read_b64_tr_b16 v[68:69], v6 offset:18016
    v_mfma_f32_16x16x32_bf16 v[160:163], v[48:51], v[88:91], v[160:163]
    ds_read_b64_tr_b16 v[70:71], v6 offset:19808
    v_mfma_f32_16x16x32_bf16 v[192:195], v[48:51], v[96:99], v[192:195]
    s_waitcnt lgkmcnt(8)
    v_mfma_f32_16x16x32_bf16 v[120:123], v[52:55], v[84:87], v[120:123]
    ds_read_b64_tr_b16 v[72:73], v6 offset:18048
    v_mfma_f32_16x16x32_bf16 v[164:167], v[52:55], v[88:91], v[164:167]
    ds_read_b64_tr_b16 v[74:75], v6 offset:19840
    v_mfma_f32_16x16x32_bf16 v[196:199], v[52:55], v[96:99], v[196:199]
    v_add_u32 v6, s35, v6
    s_barrier
    ds_read_b128 v[76:79], v24 offset:0
    ds_read_b128 v[80:83], v24 offset:2048
    ds_read_b128 v[92:95], v26
    s_waitcnt lgkmcnt(11)
    v_mfma_f32_16x16x32_bf16 v[124:127], v[56:59], v[84:87], v[124:127]
    ds_read_b64_tr_b16 v[32:33], v6 offset:0
    v_mfma_f32_16x16x32_bf16 v[168:171], v[56:59], v[88:91], v[168:171]
    ds_read_b64_tr_b16 v[34:35], v6 offset:1792
    v_mfma_f32_16x16x32_bf16 v[200:203], v[56:59], v[96:99], v[200:203]
    s_waitcnt lgkmcnt(11)
    v_mfma_f32_16x16x32_bf16 v[128:131], v[60:63], v[84:87], v[128:131]
    ds_read_b64_tr_b16 v[36:37], v6 offset:32
    v_mfma_f32_16x16x32_bf16 v[172:175], v[60:63], v[88:91], v[172:175]
    ds_read_b64_tr_b16 v[38:39], v6 offset:1824
    v_mfma_f32_16x16x32_bf16 v[204:207], v[60:63], v[96:99], v[204:207]
    s_waitcnt lgkmcnt(11)
    v_mfma_f32_16x16x32_bf16 v[132:135], v[64:67], v[84:87], v[132:135]
    ds_read_b64_tr_b16 v[40:41], v6 offset:64
    v_mfma_f32_16x16x32_bf16 v[176:179], v[64:67], v[88:91], v[176:179]
    ds_read_b64_tr_b16 v[42:43], v6 offset:1856
    v_mfma_f32_16x16x32_bf16 v[208:211], v[64:67], v[96:99], v[208:211]
    s_waitcnt lgkmcnt(11)
    v_mfma_f32_16x16x32_bf16 v[136:139], v[68:71], v[84:87], v[136:139]
    ds_read_b64_tr_b16 v[44:45], v7 offset:0
    v_mfma_f32_16x16x32_bf16 v[180:183], v[68:71], v[88:91], v[180:183]
    ds_read_b64_tr_b16 v[46:47], v7 offset:1792
    v_mfma_f32_16x16x32_bf16 v[212:215], v[68:71], v[96:99], v[212:215]
    s_waitcnt lgkmcnt(11)
    v_mfma_f32_16x16x32_bf16 v[140:143], v[72:75], v[84:87], v[140:143]
    ds_read_b64_tr_b16 v[48:49], v6 offset:7200
    v_mfma_f32_16x16x32_bf16 v[184:187], v[72:75], v[88:91], v[184:187]
    ds_read_b64_tr_b16 v[50:51], v6 offset:8992
    v_mfma_f32_16x16x32_bf16 v[216:219], v[72:75], v[96:99], v[216:219]
    s_add_u32 s36, s36, 1
    s_cmp_lt_u32 s36, 6
    s_cbranch_scc1 P1_loop_29
    s_waitcnt vmcnt(0)
    v_readfirstlane_b32 s3, v29
    s_cmp_lg_u32 s3, 0
    s_cbranch_scc1 tag_30_done
    s_mov_b32 s62, 0
tag_30:
    v_mov_b32 v29, 0
    global_load_dword v29, v29, s[80:81] sc1
    s_waitcnt vmcnt(0)
    v_readfirstlane_b32 s3, v29
    s_add_u32 s62, s62, 1
    s_cmp_gt_u32 s62, 65536
    s_cbranch_scc1 tag_30_done
    s_cmp_eq_u32 s3, 0
    s_cbranch_scc1 tag_30

tag_30_done:
    s_waitcnt lgkmcnt(8)
    v_mfma_f32_16x16x32_bf16 v[100:103], v[32:35], v[76:79], v[100:103]
    ds_read_b64_tr_b16 v[52:53], v6 offset:7232
    v_mfma_f32_16x16x32_bf16 v[144:147], v[32:35], v[80:83], v[144:147]
    ds_read_b64_tr_b16 v[54:55], v6 offset:9024
    s_waitcnt lgkmcnt(8)
    v_mfma_f32_16x16x32_bf16 v[104:107], v[36:39], v[76:79], v[104:107]
    ds_read_b64_tr_b16 v[56:57], v6 offset:7264
    v_mfma_f32_16x16x32_bf16 v[148:151], v[36:39], v[80:83], v[148:151]
    ds_read_b64_tr_b16 v[58:59], v6 offset:9056
    s_waitcnt lgkmcnt(8)
    v_mfma_f32_16x16x32_bf16 v[108:111], v[40:43], v[76:79], v[108:111]
    ds_read_b64_tr_b16 v[60:61], v6 offset:14368
    v_mfma_f32_16x16x32_bf16 v[152:155], v[40:43], v[80:83], v[152:155]
    ds_read_b64_tr_b16 v[62:63], v6 offset:16160
    s_waitcnt lgkmcnt(8)
    v_mfma_f32_16x16x32_bf16 v[112:115], v[44:47], v[76:79], v[112:115]
    ds_read_b64_tr_b16 v[64:65], v6 offset:14400
    v_mfma_f32_16x16x32_bf16 v[156:159], v[44:47], v[80:83], v[156:159]
    ds_read_b64_tr_b16 v[66:67], v6 offset:16192
    v_mfma_f32_16x16x32_bf16 v[188:191], v[44:47], v[92:95], v[188:191]
    s_waitcnt lgkmcnt(8)
    v_mfma_f32_16x16x32_bf16 v[116:119], v[48:51], v[76:79], v[116:119]
    ds_read_b64_tr_b16 v[68:69], v6 offset:14432
    v_mfma_f32_16x16x32_bf16 v[160:163], v[48:51], v[80:83], v[160:163]
    ds_read_b64_tr_b16 v[70:71], v6 offset:16224
    v_mfma_f32_16x16x32_bf16 v[192:195], v[48:51], v[92:95], v[192:195]
    s_waitcnt lgkmcnt(8)
    v_mfma_f32_16x16x32_bf16 v[120:123], v[52:55], v[76:79], v[120:123]
    ds_read_b64_tr_b16 v[72:73], v6 offset:14464
    v_mfma_f32_16x16x32_bf16 v[164:167], v[52:55], v[80:83], v[164:167]
    ds_read_b64_tr_b16 v[74:75], v6 offset:16256
    v_mfma_f32_16x16x32_bf16 v[196:199], v[52:55], v[92:95], v[196:199]
    ds_read_b128 v[84:87], v25 offset:0
    ds_read_b128 v[88:91], v25 offset:2048
    ds_read_b128 v[96:99], v27
    s_waitcnt lgkmcnt(11)
    v_mfma_f32_16x16x32_bf16 v[124:127], v[56:59], v[76:79], v[124:127]
    ds_read_b64_tr_b16 v[32:33], v6 offset:3584
    v_mfma_f32_16x16x32_bf16 v[168:171], v[56:59], v[80:83], v[168:171]
    ds_read_b64_tr_b16 v[34:35], v6 offset:5376
    v_mfma_f32_16x16x32_bf16 v[200:203], v[56:59], v[92:95], v[200:203]
    s_waitcnt lgkmcnt(11)
    v_mfma_f32_16x16x32_bf16 v[128:131], v[60:63], v[76:79], v[128:131]
    ds_read_b64_tr_b16 v[36:37], v6 offset:3616
    v_mfma_f32_16x16x32_bf16 v[172:175], v[60:63], v[80:83], v[172:175]
    ds_read_b64_tr_b16 v[38:39], v6 offset:5408
    v_mfma_f32_16x16x32_bf16 v[204:207], v[60:63], v[92:95], v[204:207]
    s_waitcnt lgkmcnt(11)
    v_mfma_f32_16x16x32_bf16 v[132:135], v[64:67], v[76:79], v[132:135]
    ds_read_b64_tr_b16 v[40:41], v6 offset:3648
    v_mfma_f32_16x16x32_bf16 v[176:179], v[64:67], v[80:83], v[176:179]
    ds_read_b64_tr_b16 v[42:43], v6 offset:5440
    v_mfma_f32_16x16x32_bf16 v[208:211], v[64:67], v[92:95], v[208:211]
    s_waitcnt lgkmcnt(11)
    v_mfma_f32_16x16x32_bf16 v[136:139], v[68:71], v[76:79], v[136:139]
    ds_read_b64_tr_b16 v[44:45], v7 offset:3584
    v_mfma_f32_16x16x32_bf16 v[180:183], v[68:71], v[80:83], v[180:183]
    ds_read_b64_tr_b16 v[46:47], v7 offset:5376
    v_mfma_f32_16x16x32_bf16 v[212:215], v[68:71], v[92:95], v[212:215]
    s_waitcnt lgkmcnt(11)
    v_mfma_f32_16x16x32_bf16 v[140:143], v[72:75], v[76:79], v[140:143]
    ds_read_b64_tr_b16 v[48:49], v6 offset:10784
    v_mfma_f32_16x16x32_bf16 v[184:187], v[72:75], v[80:83], v[184:187]
    ds_read_b64_tr_b16 v[50:51], v6 offset:12576
    v_mfma_f32_16x16x32_bf16 v[216:219], v[72:75], v[92:95], v[216:219]
    s_barrier
    ds_write_b64 v23, v[222:223] offset:0
    ds_write_b64 v23, v[224:225] offset:18432
    ds_write_b64 v23, v[222:223] offset:36864
    ds_write_b64 v226, v[228:229]
    s_waitcnt lgkmcnt(12)
    v_mfma_f32_16x16x32_bf16 v[100:103], v[32:35], v[84:87], v[100:103]
    ds_read_b64_tr_b16 v[52:53], v6 offset:10816
    v_mfma_f32_16x16x32_bf16 v[144:147], v[32:35], v[88:91], v[144:147]
    ds_read_b64_tr_b16 v[54:55], v6 offset:12608
    s_waitcnt lgkmcnt(12)
    v_mfma_f32_16x16x32_bf16 v[104:107], v[36:39], v[84:87], v[104:107]
    ds_read_b64_tr_b16 v[56:57], v6 offset:10848
    v_mfma_f32_16x16x32_bf16 v[148:151], v[36:39], v[88:91], v[148:151]
    ds_read_b64_tr_b16 v[58:59], v6 offset:12640
    s_waitcnt lgkmcnt(12)
    v_mfma_f32_16x16x32_bf16 v[108:111], v[40:43], v[84:87], v[108:111]
    ds_read_b64_tr_b16 v[60:61], v6 offset:17952
    v_mfma_f32_16x16x32_bf16 v[152:155], v[40:43], v[88:91], v[152:155]
    ds_read_b64_tr_b16 v[62:63], v6 offset:19744
    s_waitcnt lgkmcnt(12)
    v_mfma_f32_16x16x32_bf16 v[112:115], v[44:47], v[84:87], v[112:115]
    ds_read_b64_tr_b16 v[64:65], v6 offset:17984
    v_mfma_f32_16x16x32_bf16 v[156:159], v[44:47], v[88:91], v[156:159]
    ds_read_b64_tr_b16 v[66:67], v6 offset:19776
    v_mfma_f32_16x16x32_bf16 v[188:191], v[44:47], v[96:99], v[188:191]
    v_cvt_pk_bf16_f32 v100, v100, v101
    v_cvt_pk_bf16_f32 v101, v102, v103
    v_cvt_pk_bf16_f32 v144, v144, v145
    v_cvt_pk_bf16_f32 v145, v146, v147
    ds_write_b64 v12, v[100:101] offset:1024
    ds_write_b64 v12, v[144:145] offset:2048
    s_waitcnt lgkmcnt(14)
    v_mfma_f32_16x16x32_bf16 v[116:119], v[48:51], v[84:87], v[116:119]
    ds_read_b64_tr_b16 v[68:69], v6 offset:18016
    v_mfma_f32_16x16x32_bf16 v[160:163], v[48:51], v[88:91], v[160:163]
    ds_read_b64_tr_b16 v[70:71], v6 offset:19808
    v_mfma_f32_16x16x32_bf16 v[192:195], v[48:51], v[96:99], v[192:195]
    v_cvt_pk_bf16_f32 v104, v104, v105
    v_cvt_pk_bf16_f32 v105, v106, v107
    v_cvt_pk_bf16_f32 v148, v148, v149
    v_cvt_pk_bf16_f32 v149, v150, v151
    ds_write_b64 v13, v[104:105] offset:1024
    ds_write_b64 v13, v[148:149] offset:2048
    s_waitcnt lgkmcnt(12)
    v_mfma_f32_16x16x32_bf16 v[120:123], v[52:55], v[84:87], v[120:123]
    ds_read_b64_tr_b16 v[72:73], v6 offset:18048
    v_mfma_f32_16x16x32_bf16 v[164:167], v[52:55], v[88:91], v[164:167]
    ds_read_b64_tr_b16 v[74:75], v6 offset:19840
    v_mfma_f32_16x16x32_bf16 v[196:199], v[52:55], v[96:99], v[196:199]
    v_cvt_pk_bf16_f32 v108, v108, v109
    v_cvt_pk_bf16_f32 v109, v110, v111
    v_cvt_pk_bf16_f32 v152, v152, v153
    v_cvt_pk_bf16_f32 v153, v154, v155
    ds_write_b64 v14, v[108:109] offset:1024
    ds_write_b64 v14, v[152:153] offset:2048
    s_waitcnt lgkmcnt(14)
    v_mfma_f32_16x16x32_bf16 v[124:127], v[56:59], v[84:87], v[124:127]
    v_mfma_f32_16x16x32_bf16 v[168:171], v[56:59], v[88:91], v[168:171]
    v_mfma_f32_16x16x32_bf16 v[200:203], v[56:59], v[96:99], v[200:203]
    v_cvt_pk_bf16_f32 v112, v112, v113
    v_cvt_pk_bf16_f32 v113, v114, v115
    v_cvt_pk_bf16_f32 v156, v156, v157
    v_cvt_pk_bf16_f32 v157, v158, v159
    ds_write_b64 v15, v[112:113] offset:1024
    ds_write_b64 v15, v[156:157] offset:2048
    s_waitcnt lgkmcnt(14)
    v_mfma_f32_16x16x32_bf16 v[128:131], v[60:63], v[84:87], v[128:131]
    v_mfma_f32_16x16x32_bf16 v[172:175], v[60:63], v[88:91], v[172:175]
    v_mfma_f32_16x16x32_bf16 v[204:207], v[60:63], v[96:99], v[204:207]
    v_cvt_pk_bf16_f32 v116, v116, v117
    v_cvt_pk_bf16_f32 v117, v118, v119
    v_cvt_pk_bf16_f32 v160, v160, v161
    v_cvt_pk_bf16_f32 v161, v162, v163
    ds_write_b64 v16, v[116:117] offset:1024
    ds_write_b64 v16, v[160:161] offset:2048
    s_waitcnt lgkmcnt(14)
    v_mfma_f32_16x16x32_bf16 v[132:135], v[64:67], v[84:87], v[132:135]
    v_mfma_f32_16x16x32_bf16 v[176:179], v[64:67], v[88:91], v[176:179]
    v_mfma_f32_16x16x32_bf16 v[208:211], v[64:67], v[96:99], v[208:211]
    v_cvt_pk_bf16_f32 v120, v120, v121
    v_cvt_pk_bf16_f32 v121, v122, v123
    v_cvt_pk_bf16_f32 v164, v164, v165
    v_cvt_pk_bf16_f32 v165, v166, v167
    ds_write_b64 v17, v[120:121] offset:1024
    ds_write_b64 v17, v[164:165] offset:2048
    s_waitcnt lgkmcnt(12)
    v_mfma_f32_16x16x32_bf16 v[136:139], v[68:71], v[84:87], v[136:139]
    v_mfma_f32_16x16x32_bf16 v[180:183], v[68:71], v[88:91], v[180:183]
    v_mfma_f32_16x16x32_bf16 v[212:215], v[68:71], v[96:99], v[212:215]
    v_cvt_pk_bf16_f32 v124, v124, v125
    v_cvt_pk_bf16_f32 v125, v126, v127
    v_cvt_pk_bf16_f32 v168, v168, v169
    v_cvt_pk_bf16_f32 v169, v170, v171
    ds_write_b64 v18, v[124:125] offset:1024
    ds_write_b64 v18, v[168:169] offset:2048
    s_waitcnt lgkmcnt(10)
    v_mfma_f32_16x16x32_bf16 v[140:143], v[72:75], v[84:87], v[140:143]
    v_mfma_f32_16x16x32_bf16 v[184:187], v[72:75], v[88:91], v[184:187]
    v_mfma_f32_16x16x32_bf16 v[216:219], v[72:75], v[96:99], v[216:219]
    v_cvt_pk_bf16_f32 v128, v128, v129
    v_cvt_pk_bf16_f32 v129, v130, v131
    v_cvt_pk_bf16_f32 v172, v172, v173
    v_cvt_pk_bf16_f32 v173, v174, v175
    ds_write_b64 v19, v[128:129] offset:1024
    ds_write_b64 v19, v[172:173] offset:2048
    v_cvt_pk_bf16_f32 v132, v132, v133
    v_cvt_pk_bf16_f32 v133, v134, v135
    v_cvt_pk_bf16_f32 v176, v176, v177
    v_cvt_pk_bf16_f32 v177, v178, v179
    ds_write_b64 v20, v[132:133] offset:1024
    ds_write_b64 v20, v[176:177] offset:2048
    v_cvt_pk_bf16_f32 v136, v136, v137
    v_cvt_pk_bf16_f32 v137, v138, v139
    v_cvt_pk_bf16_f32 v180, v180, v181
    v_cvt_pk_bf16_f32 v181, v182, v183
    ds_write_b64 v21, v[136:137] offset:1024
    ds_write_b64 v21, v[180:181] offset:2048
    v_cvt_pk_bf16_f32 v140, v140, v141
    v_cvt_pk_bf16_f32 v141, v142, v143
    v_cvt_pk_bf16_f32 v184, v184, v185
    v_cvt_pk_bf16_f32 v185, v186, v187
    ds_write_b64 v22, v[140:141] offset:1024
    ds_write_b64 v22, v[184:185] offset:2048
    s_cmp_lg_u32 s56, 0
    s_cbranch_scc1 halo_n_32
    v_cvt_pk_bf16_f32 v188, v188, v189
    v_cvt_pk_bf16_f32 v189, v190, v191
    s_nop 0
    ds_write_b64 v15, v[188:189] offset:0
    v_cvt_pk_bf16_f32 v192, v192, v193
    v_cvt_pk_bf16_f32 v193, v194, v195
    s_nop 0
    ds_write_b64 v16, v[192:193] offset:0
    s_branch halo_j_31
halo_n_32:
    s_cmp_lg_u32 s56, 1
    s_cbranch_scc1 halo_n_33
    v_cvt_pk_bf16_f32 v196, v196, v197
    v_cvt_pk_bf16_f32 v197, v198, v199
    v_subrev_u32 v17, 2048, v17
    ds_write_b64 v17, v[196:197] offset:0
    v_cvt_pk_bf16_f32 v200, v200, v201
    v_cvt_pk_bf16_f32 v201, v202, v203
    v_subrev_u32 v18, 2048, v18
    ds_write_b64 v18, v[200:201] offset:0
    s_branch halo_j_31
halo_n_33:
    s_cmp_lg_u32 s56, 2
    s_cbranch_scc1 halo_n_34
    v_cvt_pk_bf16_f32 v204, v204, v205
    v_cvt_pk_bf16_f32 v205, v206, v207
    v_subrev_u32 v19, 4096, v19
    ds_write_b64 v19, v[204:205] offset:0
    v_cvt_pk_bf16_f32 v208, v208, v209
    v_cvt_pk_bf16_f32 v209, v210, v211
    v_subrev_u32 v20, 4096, v20
    ds_write_b64 v20, v[208:209] offset:0
    s_branch halo_j_31
halo_n_34:
    v_cvt_pk_bf16_f32 v212, v212, v213
    v_cvt_pk_bf16_f32 v213, v214, v215
    v_subrev_u32 v21, 6144, v21
    ds_write_b64 v21, v[212:213] offset:0
    v_cvt_pk_bf16_f32 v216, v216, v217
    v_cvt_pk_bf16_f32 v217, v218, v219
    v_subrev_u32 v22, 6144, v22
    ds_write_b64 v22, v[216:217] offset:0
halo_n_35:
halo_j_31:
    s_waitcnt lgkmcnt(0)
    s_barrier
    s_mov_b32 s12, s82
    s_mov_b32 s13, s83
    s_mov_b32 s14, 10633216
    s_mov_b32 s15, 0x20000
    ds_read_b128 v[32:35], v230 offset:1024
    ds_read_b128 v[36:39], v230 offset:18432
    ds_read_b128 v[40:43], v230 offset:19456
    ds_read_b128 v[72:75], v230 offset:2048
    ds_read_b128 v[76:79], v230 offset:19456
    ds_read_b128 v[80:83], v230 offset:20480
    ds_read_b128 v[112:115], v230 offset:10240
    ds_read_b128 v[116:119], v230 offset:27648
    ds_read_b128 v[120:123], v230 offset:28672
    ds_read_b128 v[152:155], v230 offset:11264
    ds_read_b128 v[156:159], v230 offset:28672
    ds_read_b128 v[160:163], v230 offset:29696
    s_mov_b32 s24, 1049335798
    s_mov_b32 s26, 1049335798
    s_mov_b32 s27, 1049335798
    s_waitcnt lgkmcnt(9)
    v_mfma_f32_16x16x32_bf16 v[52:55], v[36:39], v[32:35], v[244:247]
    v_mfma_f32_16x16x32_bf16 v[56:59], v[40:43], v[32:35], v[240:243]
    ds_read_b64_tr_b16 v[44:45], v231 offset:36864
    ds_read_b64_tr_b16 v[46:47], v231 offset:37888
    ds_read_b64_tr_b16 v[48:49], v232 offset:36864
    ds_read_b64_tr_b16 v[50:51], v232 offset:37888
    s_waitcnt lgkmcnt(10)
    v_mfma_f32_16x16x32_bf16 v[92:95], v[76:79], v[72:75], v[236:239]
    v_mfma_f32_16x16x32_bf16 v[96:99], v[80:83], v[72:75], v[240:243]
    ds_read_b64_tr_b16 v[84:85], v231 offset:37888
    ds_read_b64_tr_b16 v[86:87], v231 offset:38912
    ds_read_b64_tr_b16 v[88:89], v232 offset:37888
    ds_read_b64_tr_b16 v[90:91], v232 offset:38912
    s_waitcnt lgkmcnt(11)
    v_mfma_f32_16x16x32_bf16 v[132:135], v[116:119], v[112:115], v[244:247]
    v_mfma_f32_16x16x32_bf16 v[136:139], v[120:123], v[112:115], v[240:243]
    ds_read_b64_tr_b16 v[124:125], v231 offset:46080
    ds_read_b64_tr_b16 v[126:127], v231 offset:47104
    ds_read_b64_tr_b16 v[128:129], v232 offset:46080
    ds_read_b64_tr_b16 v[130:131], v232 offset:47104
    s_waitcnt lgkmcnt(12)
    v_mfma_f32_16x16x32_bf16 v[172:175], v[156:159], v[152:155], v[236:239]
    v_mfma_f32_16x16x32_bf16 v[176:179], v[160:163], v[152:155], v[240:243]
    ds_read_b64_tr_b16 v[164:165], v231 offset:47104
    ds_read_b64_tr_b16 v[166:167], v231 offset:48128
    ds_read_b64_tr_b16 v[168:169], v232 offset:47104
    ds_read_b64_tr_b16 v[170:171], v232 offset:48128
    s_nop 1
    v_max3_f32 v68, v52, v53, v54
    v_max3_f32 v108, v92, v93, v94
    v_max3_f32 v148, v132, v133, v134
    v_max3_f32 v188, v172, v173, v174
    v_max3_f32 v69, v55, v56, v57
    v_max3_f32 v109, v95, v96, v97
    v_max3_f32 v149, v135, v136, v137
    v_max3_f32 v189, v175, v176, v177
    v_max3_f32 v68, v68, v58, v59
    v_max3_f32 v108, v108, v98, v99
    v_max3_f32 v148, v148, v138, v139
    v_max3_f32 v188, v188, v178, v179
    v_max_f32 v68, v68, v69
    v_max_f32 v108, v108, v109
    v_max_f32 v148, v148, v149
    v_max_f32 v188, v188, v189
    v_mov_b32 v69, v68
    v_mov_b32 v109, v108
    v_mov_b32 v149, v148
    v_mov_b32 v189, v188
    v_permlane32_swap_b32 v68, v69
    v_permlane32_swap_b32 v108, v109
    v_permlane32_swap_b32 v148, v149
    v_permlane32_swap_b32 v188, v189
    v_max_f32 v68, v68, v69
    v_max_f32 v108, v108, v109
    v_max_f32 v148, v148, v149
    v_max_f32 v188, v188, v189
    v_mov_b32 v69, v68
    v_mov_b32 v109, v108
    v_mov_b32 v149, v148
    v_mov_b32 v189, v188
    v_permlane16_swap_b32 v68, v69
    v_permlane16_swap_b32 v108, v109
    v_permlane16_swap_b32 v148, v149
    v_permlane16_swap_b32 v188, v189
    v_max_f32 v68, v68, v69
    v_max_f32 v108, v108, v109
    v_max_f32 v148, v148, v149
    v_max_f32 v188, v188, v189
    v_mul_f32 v68, s24, v68
    v_mul_f32 v108, s24, v108
    v_mul_f32 v148, s24, v148
    v_mul_f32 v188, s24, v188
    v_pk_fma_f32 v[52:53], v[52:53], s[26:27], v[68:69] op_sel_hi:[1,0,0] neg_lo:[0,0,1] neg_hi:[0,0,1]
    v_pk_fma_f32 v[92:93], v[92:93], s[26:27], v[108:109] op_sel_hi:[1,0,0] neg_lo:[0,0,1] neg_hi:[0,0,1]
    v_pk_fma_f32 v[132:133], v[132:133], s[26:27], v[148:149] op_sel_hi:[1,0,0] neg_lo:[0,0,1] neg_hi:[0,0,1]
    v_pk_fma_f32 v[172:173], v[172:173], s[26:27], v[188:189] op_sel_hi:[1,0,0] neg_lo:[0,0,1] neg_hi:[0,0,1]
    v_pk_fma_f32 v[54:55], v[54:55], s[26:27], v[68:69] op_sel_hi:[1,0,0] neg_lo:[0,0,1] neg_hi:[0,0,1]
    v_pk_fma_f32 v[94:95], v[94:95], s[26:27], v[108:109] op_sel_hi:[1,0,0] neg_lo:[0,0,1] neg_hi:[0,0,1]
    v_pk_fma_f32 v[134:135], v[134:135], s[26:27], v[148:149] op_sel_hi:[1,0,0] neg_lo:[0,0,1] neg_hi:[0,0,1]
    v_pk_fma_f32 v[174:175], v[174:175], s[26:27], v[188:189] op_sel_hi:[1,0,0] neg_lo:[0,0,1] neg_hi:[0,0,1]
    v_pk_fma_f32 v[56:57], v[56:57], s[26:27], v[68:69] op_sel_hi:[1,0,0] neg_lo:[0,0,1] neg_hi:[0,0,1]
    v_pk_fma_f32 v[96:97], v[96:97], s[26:27], v[108:109] op_sel_hi:[1,0,0] neg_lo:[0,0,1] neg_hi:[0,0,1]
    v_pk_fma_f32 v[136:137], v[136:137], s[26:27], v[148:149] op_sel_hi:[1,0,0] neg_lo:[0,0,1] neg_hi:[0,0,1]
    v_pk_fma_f32 v[176:177], v[176:177], s[26:27], v[188:189] op_sel_hi:[1,0,0] neg_lo:[0,0,1] neg_hi:[0,0,1]
    v_pk_fma_f32 v[58:59], v[58:59], s[26:27], v[68:69] op_sel_hi:[1,0,0] neg_lo:[0,0,1] neg_hi:[0,0,1]
    v_pk_fma_f32 v[98:99], v[98:99], s[26:27], v[108:109] op_sel_hi:[1,0,0] neg_lo:[0,0,1] neg_hi:[0,0,1]
    v_pk_fma_f32 v[138:139], v[138:139], s[26:27], v[148:149] op_sel_hi:[1,0,0] neg_lo:[0,0,1] neg_hi:[0,0,1]
    v_pk_fma_f32 v[178:179], v[178:179], s[26:27], v[188:189] op_sel_hi:[1,0,0] neg_lo:[0,0,1] neg_hi:[0,0,1]
    v_exp_f32 v52, v52
    v_exp_f32 v92, v92
    v_exp_f32 v132, v132
    v_exp_f32 v172, v172
    v_exp_f32 v53, v53
    v_exp_f32 v93, v93
    v_exp_f32 v133, v133
    v_exp_f32 v173, v173
    v_exp_f32 v54, v54
    v_exp_f32 v94, v94
    v_exp_f32 v134, v134
    v_exp_f32 v174, v174
    v_exp_f32 v55, v55
    v_exp_f32 v95, v95
    v_exp_f32 v135, v135
    v_exp_f32 v175, v175
    v_exp_f32 v56, v56
    v_exp_f32 v96, v96
    v_exp_f32 v136, v136
    v_exp_f32 v176, v176
    v_exp_f32 v57, v57
    v_exp_f32 v97, v97
    v_exp_f32 v137, v137
    v_exp_f32 v177, v177
    v_exp_f32 v58, v58
    v_exp_f32 v98, v98
    v_exp_f32 v138, v138
    v_exp_f32 v178, v178
    v_exp_f32 v59, v59
    v_exp_f32 v99, v99
    v_exp_f32 v139, v139
    v_exp_f32 v179, v179
    v_cvt_pk_bf16_f32 v52, v52, v53
    v_cvt_pk_bf16_f32 v92, v92, v93
    v_cvt_pk_bf16_f32 v132, v132, v133
    v_cvt_pk_bf16_f32 v172, v172, v173
    v_cvt_pk_bf16_f32 v53, v54, v55
    v_cvt_pk_bf16_f32 v93, v94, v95
    v_cvt_pk_bf16_f32 v133, v134, v135
    v_cvt_pk_bf16_f32 v173, v174, v175
    v_cvt_pk_bf16_f32 v54, v56, v57
    v_cvt_pk_bf16_f32 v94, v96, v97
    v_cvt_pk_bf16_f32 v134, v136, v137
    v_cvt_pk_bf16_f32 v174, v176, v177
    v_cvt_pk_bf16_f32 v55, v58, v59
    v_cvt_pk_bf16_f32 v95, v98, v99
    v_cvt_pk_bf16_f32 v135, v138, v139
    v_cvt_pk_bf16_f32 v175, v178, v179
    s_waitcnt lgkmcnt(12)
    v_mfma_f32_16x16x32_bf16 v[60:63], v[44:47], v[52:55], 0
    v_mfma_f32_16x16x32_bf16 v[64:67], v[48:51], v[52:55], 0
    s_waitcnt lgkmcnt(8)
    v_mfma_f32_16x16x32_bf16 v[100:103], v[84:87], v[92:95], 0
    v_mfma_f32_16x16x32_bf16 v[104:107], v[88:91], v[92:95], 0
    s_waitcnt lgkmcnt(4)
    v_mfma_f32_16x16x32_bf16 v[140:143], v[124:127], v[132:135], 0
    v_mfma_f32_16x16x32_bf16 v[144:147], v[128:131], v[132:135], 0
    s_waitcnt lgkmcnt(0)
    v_mfma_f32_16x16x32_bf16 v[180:183], v[164:167], v[172:175], 0
    v_mfma_f32_16x16x32_bf16 v[184:187], v[168:171], v[172:175], 0
    v_cmp_gt_u32 vcc, 48, v1
    v_mov_b32 v8, s3
    s_lshl_b32 s23, s18, 1
    s_add_u32 s23, s23, 16
    s_mul_i32 s23, s23, 131072
    s_lshl_b32 s24, s17, 13
    s_add_u32 s23, s23, s24
    s_lshl_b32 s24, s56, 11
    s_add_u32 s23, s23, s24
    s_add_u32 s23, s23, 6291456

    v_mov_b32 v69, v64
    v_mov_b32 v109, v104
    v_mov_b32 v149, v144
    v_mov_b32 v189, v184
    v_mov_b32 v70, v64
    v_mov_b32 v110, v104
    v_mov_b32 v150, v144
    v_mov_b32 v190, v184
    v_permlane32_swap_b32 v69, v70
    v_permlane32_swap_b32 v109, v110
    v_permlane32_swap_b32 v149, v150
    v_permlane32_swap_b32 v189, v190
    v_mov_b32 v69, v70
    v_mov_b32 v109, v110
    v_mov_b32 v149, v150
    v_mov_b32 v189, v190
    s_nop 0
    v_permlane16_swap_b32 v69, v70
    v_permlane16_swap_b32 v109, v110
    v_permlane16_swap_b32 v149, v150
    v_permlane16_swap_b32 v189, v190
    v_rcp_f32 v70, v70
    v_rcp_f32 v110, v110
    v_rcp_f32 v150, v150
    v_rcp_f32 v190, v190
    s_nop 0
    v_pk_mul_f32 v[60:61], v[60:61], v[70:71] op_sel_hi:[1,0]
    v_pk_mul_f32 v[100:101], v[100:101], v[110:111] op_sel_hi:[1,0]
    v_pk_mul_f32 v[140:141], v[140:141], v[150:151] op_sel_hi:[1,0]
    v_pk_mul_f32 v[180:181], v[180:181], v[190:191] op_sel_hi:[1,0]
    v_pk_mul_f32 v[62:63], v[62:63], v[70:71] op_sel_hi:[1,0]
    v_pk_mul_f32 v[102:103], v[102:103], v[110:111] op_sel_hi:[1,0]
    v_pk_mul_f32 v[142:143], v[142:143], v[150:151] op_sel_hi:[1,0]
    v_pk_mul_f32 v[182:183], v[182:183], v[190:191] op_sel_hi:[1,0]
    v_pk_mul_f32 v[64:65], v[64:65], v[70:71] op_sel_hi:[1,0]
    v_pk_mul_f32 v[104:105], v[104:105], v[110:111] op_sel_hi:[1,0]
    v_pk_mul_f32 v[144:145], v[144:145], v[150:151] op_sel_hi:[1,0]
    v_pk_mul_f32 v[184:185], v[184:185], v[190:191] op_sel_hi:[1,0]
    v_pk_mul_f32 v[66:67], v[66:67], v[70:71] op_sel_hi:[1,0]
    v_pk_mul_f32 v[106:107], v[106:107], v[110:111] op_sel_hi:[1,0]
    v_pk_mul_f32 v[146:147], v[146:147], v[150:151] op_sel_hi:[1,0]
    v_pk_mul_f32 v[186:187], v[186:187], v[190:191] op_sel_hi:[1,0]
    v_cvt_pk_bf16_f32 v60, v60, v61
    v_cvt_pk_bf16_f32 v100, v100, v101
    v_cvt_pk_bf16_f32 v140, v140, v141
    v_cvt_pk_bf16_f32 v180, v180, v181
    v_cvt_pk_bf16_f32 v61, v62, v63
    v_cvt_pk_bf16_f32 v101, v102, v103
    v_cvt_pk_bf16_f32 v141, v142, v143
    v_cvt_pk_bf16_f32 v181, v182, v183
    v_cvt_pk_bf16_f32 v62, v64, v65
    v_cvt_pk_bf16_f32 v102, v104, v105
    v_cvt_pk_bf16_f32 v142, v144, v145
    v_cvt_pk_bf16_f32 v182, v184, v185
    v_cvt_pk_bf16_f32 v63, v66, v67
    v_cvt_pk_bf16_f32 v103, v106, v107
    v_cvt_pk_bf16_f32 v143, v146, v147
    v_cvt_pk_bf16_f32 v183, v186, v187
    v_cndmask_b32 v62, 0, v62, vcc
    v_cndmask_b32 v102, 0, v102, vcc
    v_cndmask_b32 v142, 0, v142, vcc
    v_cndmask_b32 v182, 0, v182, vcc
    v_cndmask_b32 v63, v8, v63, vcc
    v_cndmask_b32 v103, v8, v103, vcc
    v_cndmask_b32 v143, v8, v143, vcc
    v_cndmask_b32 v183, v8, v183, vcc
    ds_write_b64 v233, v[60:61] offset:0
    ds_write_b64 v234, v[62:63] offset:0
    ds_write_b64 v233, v[100:101] offset:1024
    ds_write_b64 v234, v[102:103] offset:1024
    ds_write_b64 v233, v[140:141] offset:2048
    ds_write_b64 v234, v[142:143] offset:2048
    ds_write_b64 v233, v[180:181] offset:3072
    ds_write_b64 v234, v[182:183] offset:3072
    v_lshlrev_b32 v8, 4, v1
    s_waitcnt lgkmcnt(0)
    ds_read_b128 v[32:35], v235 offset:0
    ds_read_b128 v[72:75], v235 offset:1024
    ds_read_b128 v[112:115], v235 offset:2048
    ds_read_b128 v[152:155], v235 offset:3072
    s_waitcnt lgkmcnt(3)
    s_add_u32 s25, s23, 0
    buffer_store_dwordx4 v[32:35], v8, s[12:15], s25 offen sc1
    s_waitcnt lgkmcnt(2)
    s_add_u32 s25, s23, 1024
    buffer_store_dwordx4 v[72:75], v8, s[12:15], s25 offen sc1
    s_waitcnt lgkmcnt(1)
    s_add_u32 s25, s23, 131072
    buffer_store_dwordx4 v[112:115], v8, s[12:15], s25 offen sc1
    s_waitcnt lgkmcnt(0)
    s_add_u32 s25, s23, 132096
    buffer_store_dwordx4 v[152:155], v8, s[12:15], s25 offen sc1
P2_START:
    s_lshr_b32 s21, s58, 4
    s_lshl_b32 s23, s57, 1
    s_add_u32 s21, s21, s23
    s_and_b32 s22, s58, 15
    s_mul_i32 s23, s21, 131072
    s_add_u32 s24, s23, 6291456
    s_add_u32 s40, s82, s24
    s_addc_u32 s41, s83, 0
    s_mov_b32 s42, 131072
    s_mov_b32 s43, 0x20000

    v_lshlrev_b32 v75, 4, v1
    v_and_b32 v2, 31, v1
    v_bfe_u32 v3, v1, 2, 2

    v_and_b32 v4, 1, v3
    v_lshlrev_b32 v4, 1, v4
    v_lshrrev_b32 v5, 1, v3
    v_mul_u32_u24 v5, 3, v5
    v_xor_b32 v4, v4, v5

    v_lshrrev_b32 v3, 5, v1
    v_lshlrev_b32 v74, 4, v4
    v_lshl_add_u32 v74, v2, 6, v74
    v_lshl_add_u32 v74, v3, 3, v74
    s_lshl_b32 s23, s56, 11
    s_add_u32 s23, s23, 16384
    v_add_u32 v74, s23, v74
    v_xor_b32 v4, v4, v3
    v_lshlrev_b32 v4, 4, v4
    s_lshl_b32 s23, s56, 5
    v_add_u32 v5, s23, v2
    v_lshl_add_u32 v6, v5, 6, v4
    v_xor_b32 v7, 32, v6

    v_lshrrev_b32 v2, 5, v1
    v_add_u32 v3, 0, v2
    v_and_b32 v4, 1, v3
    v_lshlrev_b32 v4, 1, v4
    v_lshrrev_b32 v5, 1, v3
    v_mul_u32_u24 v5, 3, v5
    v_xor_b32 v4, v4, v5

    v_bfe_u32 v5, v1, 4, 1
    v_lshlrev_b32 v5, 1, v5
    v_xor_b32 v4, v4, v5
    v_bfe_u32 v5, v1, 1, 1
    v_xor_b32 v4, v4, v5
    v_lshlrev_b32 v4, 4, v4
    v_and_b32 v5, 1, v1
    v_lshl_add_u32 v4, v5, 3, v4
    v_lshlrev_b32 v3, 2, v3
    v_bfe_u32 v5, v1, 2, 2
    v_add_u32 v3, v3, v5
    s_lshl_b32 s23, s56, 5
    v_add_u32 v3, s23, v3
    v_lshl_add_u32 v8, v3, 6, v4
    v_add_u32 v8, 24576, v8

    v_lshrrev_b32 v2, 5, v1
    v_add_u32 v3, 2, v2
    v_and_b32 v4, 1, v3
    v_lshlrev_b32 v4, 1, v4
    v_lshrrev_b32 v5, 1, v3
    v_mul_u32_u24 v5, 3, v5
    v_xor_b32 v4, v4, v5

    v_bfe_u32 v5, v1, 4, 1
    v_lshlrev_b32 v5, 1, v5
    v_xor_b32 v4, v4, v5
    v_bfe_u32 v5, v1, 1, 1
    v_xor_b32 v4, v4, v5
    v_lshlrev_b32 v4, 4, v4
    v_and_b32 v5, 1, v1
    v_lshl_add_u32 v4, v5, 3, v4
    v_lshlrev_b32 v3, 2, v3
    v_bfe_u32 v5, v1, 2, 2
    v_add_u32 v3, v3, v5
    s_lshl_b32 s23, s56, 5
    v_add_u32 v3, s23, v3
    v_lshl_add_u32 v9, v3, 6, v4
    v_add_u32 v9, 24576, v9

    v_and_b32 v2, 31, v1
    v_lshrrev_b32 v3, 5, v1
    v_lshlrev_b32 v3, 2, v3
    v_sub_u32 v2, v2, v3
    v_mov_b32 v5, 4286578688

    v_cmp_gt_i32 vcc, 0, v2
    v_cmp_gt_i32 s[60:61], 1, v2
    s_nop 0
    v_cndmask_b32 v76, v5, 0, vcc
    v_cndmask_b32 v204, 0, v5, vcc
    v_cndmask_b32 v77, v5, 0, s[60:61]
    v_cndmask_b32 v205, 0, v5, s[60:61]

    v_cmp_gt_i32 vcc, 2, v2
    v_cmp_gt_i32 s[60:61], 3, v2
    s_nop 0
    v_cndmask_b32 v78, v5, 0, vcc
    v_cndmask_b32 v206, 0, v5, vcc
    v_cndmask_b32 v79, v5, 0, s[60:61]
    v_cndmask_b32 v207, 0, v5, s[60:61]

    v_cmp_gt_i32 vcc, 8, v2
    v_cmp_gt_i32 s[60:61], 9, v2
    s_nop 0
    v_cndmask_b32 v80, v5, 0, vcc
    v_cndmask_b32 v208, 0, v5, vcc
    v_cndmask_b32 v81, v5, 0, s[60:61]
    v_cndmask_b32 v209, 0, v5, s[60:61]

    v_cmp_gt_i32 vcc, 10, v2
    v_cmp_gt_i32 s[60:61], 11, v2
    s_nop 0
    v_cndmask_b32 v82, v5, 0, vcc
    v_cndmask_b32 v210, 0, v5, vcc
    v_cndmask_b32 v83, v5, 0, s[60:61]
    v_cndmask_b32 v211, 0, v5, s[60:61]

    v_cmp_gt_i32 vcc, 16, v2
    v_cmp_gt_i32 s[60:61], 17, v2
    s_nop 0
    v_cndmask_b32 v84, v5, 0, vcc
    v_cndmask_b32 v212, 0, v5, vcc
    v_cndmask_b32 v85, v5, 0, s[60:61]
    v_cndmask_b32 v213, 0, v5, s[60:61]

    v_cmp_gt_i32 vcc, 18, v2
    v_cmp_gt_i32 s[60:61], 19, v2
    s_nop 0
    v_cndmask_b32 v86, v5, 0, vcc
    v_cndmask_b32 v214, 0, v5, vcc
    v_cndmask_b32 v87, v5, 0, s[60:61]
    v_cndmask_b32 v215, 0, v5, s[60:61]

    v_cmp_gt_i32 vcc, 24, v2
    v_cmp_gt_i32 s[60:61], 25, v2
    s_nop 0
    v_cndmask_b32 v88, v5, 0, vcc
    v_cndmask_b32 v216, 0, v5, vcc
    v_cndmask_b32 v89, v5, 0, s[60:61]
    v_cndmask_b32 v217, 0, v5, s[60:61]

    v_cmp_gt_i32 vcc, 26, v2
    v_cmp_gt_i32 s[60:61], 27, v2
    s_nop 0
    v_cndmask_b32 v90, v5, 0, vcc
    v_cndmask_b32 v218, 0, v5, vcc
    v_cndmask_b32 v91, v5, 0, s[60:61]
    v_cndmask_b32 v219, 0, v5, s[60:61]

    v_lshlrev_b32 v10, 2, v1
    v_add_u32 v10, 163712, v10

    s_mul_i32 s23, s58, 37
    s_lshr_b32 s23, s23, 8
    s_mul_i32 s24, s23, 7
    s_sub_u32 s101, s58, s24
    s_lshl_b32 s100, s57, 2
    s_add_u32 s100, s100, s23

    s_lshl_b32 s23, s59, 10
    s_lshl_b32 s52, s100, 12
    s_add_u32 s52, s52, s23

    s_add_u32 s92, s82, 6291456
    s_addc_u32 s93, s83, 0
    s_mov_b32 s94, 4194304
    s_mov_b32 s95, 0x20000
    v_lshrrev_b32 v3, 4, v1
    v_lshrrev_b32 v4, 1, v3
    v_lshlrev_b32 v4, 3, v4
    v_and_b32 v5, 1, v3
    v_lshl_add_u32 v4, v5, 2, v4
    v_bfe_u32 v5, v1, 2, 2
    v_add_u32 v4, v4, v5
    v_bfe_u32 v5, v4, 1, 2
    v_lshlrev_b32 v4, 7, v4
    v_and_b32 v2, 3, v1
    v_lshl_add_u32 v4, v2, 3, v4
    v_add_u32 v4, 49152, v4

    v_xor_b32 v2, 0, v5
    v_lshl_add_u32 v229, v2, 5, v4
    v_xor_b32 v2, 1, v5
    v_lshl_add_u32 v230, v2, 5, v4
    v_xor_b32 v2, 2, v5
    v_lshl_add_u32 v231, v2, 5, v4
    v_xor_b32 v2, 3, v5
    v_lshl_add_u32 v232, v2, 5, v4
    v_and_b32 v2, 15, v1
    v_lshrrev_b32 v3, 2, v2
    v_and_b32 v4, 1, v3
    v_lshlrev_b32 v4, 1, v4
    v_lshrrev_b32 v5, 1, v3
    v_mul_u32_u24 v5, 3, v5
    v_xor_b32 v4, v4, v5

    v_lshrrev_b32 v3, 4, v1
    v_xor_b32 v4, v4, v3
    v_lshlrev_b32 v4, 4, v4
    v_lshl_add_u32 v228, v2, 6, v4

    v_lshlrev_b32 v234, 4, v1
    s_lshl_b32 s23, s59, 10
    v_add_u32 v228, s23, v228
    s_lshl_b32 s23, s100, 6
    s_lshl_b32 s24, s59, 4
    s_add_u32 s23, s23, s24
    v_add_u32 v4, s23, v2
    v_lshlrev_b32 v4, 3, v4
    v_add_u32 v233, 10485760, v4
    s_lshl_b32 s24, s59, 12
    s_add_u32 s60, s24, 0
    s_cmp_lt_u32 s59, 2
    s_mov_b32 s61, 144896
    s_cselect_b32 s61, 114688, s61
    s_add_u32 s61, s61, s24
    v_lshrrev_b32 v4, 4, v1
    v_xor_b32 v4, v4, v2
    v_lshlrev_b32 v4, 4, v4
    v_lshl_add_u32 v4, v2, 8, v4
    v_add_u32 v241, s60, v4
    v_lshrrev_b32 v4, 3, v1
    v_add_u32 v4, 0, v4
    v_and_b32 v5, 7, v1
    v_lshlrev_b32 v3, 1, v5
    v_xor_b32 v3, v3, v4
    v_lshlrev_b32 v3, 4, v3
    v_lshl_add_u32 v3, v4, 8, v3
    v_add_u32 v239, s60, v3
    v_add_u32 v240, s61, v3
    v_add_u32 v4, s23, v4
    v_mul_u32_u24 v4, 896, v4
    v_lshl_add_u32 v238, v5, 4, v4

    s_mov_b32 s88, s78
    s_mov_b32 s89, s79
    s_mov_b32 s90, 1835008
    s_mov_b32 s91, 0x20000
    s_mov_b32 s96, s68
    s_mov_b32 s97, s69
    s_mov_b32 s98, 401408
    s_mov_b32 s99, 0x20000
    v_mov_b32 v235, 2147483648
    v_mov_b32 v236, 2147483648
    v_mul_u32_u24 v2, 512, v2
    v_lshlrev_b32 v2, 8, v2
    s_lshl_b32 s24, s100, 12
    s_add_u32 s24, s24, 6295532
    v_add_u32 v237, s24, v2

    s_cmp_eq_u32 s19, 1
    s_cbranch_scc1 P2_noV_36
    s_cmp_lt_u32 s18, 6
    s_cbranch_scc1 vco_37
    v_lshlrev_b32 v2, 4, v1
    s_lshl_b32 s23, s56, 10
    v_add_u32 v2, s23, v2
    s_mul_i32 s24, s18, 786432
    s_lshl_b32 s25, s17, 13
    s_add_u32 s24, s24, s25

    ds_read_b128 v[100:103], v2 offset:0
    ds_read_b128 v[104:107], v2 offset:8192
    ds_read_b128 v[108:111], v2 offset:16384
    ds_read_b128 v[112:115], v2 offset:24576
    ds_read_b128 v[116:119], v2 offset:32768
    ds_read_b128 v[120:123], v2 offset:40960
    s_waitcnt lgkmcnt(5)
    s_add_u32 s25, s24, 0
    buffer_store_dwordx4 v[100:103], v2, s[12:15], s25 offen sc1
    s_waitcnt lgkmcnt(4)
    s_add_u32 s25, s24, 131072
    buffer_store_dwordx4 v[104:107], v2, s[12:15], s25 offen sc1
    s_waitcnt lgkmcnt(3)
    s_add_u32 s25, s24, 262144
    buffer_store_dwordx4 v[108:111], v2, s[12:15], s25 offen sc1
    s_waitcnt lgkmcnt(2)
    s_add_u32 s25, s24, 393216
    buffer_store_dwordx4 v[112:115], v2, s[12:15], s25 offen sc1
    s_waitcnt lgkmcnt(1)
    s_add_u32 s25, s24, 524288
    buffer_store_dwordx4 v[116:119], v2, s[12:15], s25 offen sc1
    s_waitcnt lgkmcnt(0)
    s_add_u32 s25, s24, 655360
    buffer_store_dwordx4 v[120:123], v2, s[12:15], s25 offen sc1
vco_37:
    s_waitcnt lgkmcnt(0)
    s_barrier
    s_branch P2_noV_36_done
P2_noV_36:
P2_noV_36_done:
    s_mov_b32 s26, 1049335798
    s_mov_b32 s27, 1049335798
    v_add_u32 v2, 115712, v6
    v_add_u32 v3, 115712, v7
    v_mov_b32 v70, 4286578688
    v_cmp_gt_u32 vcc, 32, v1
    s_barrier
    ds_read_b128 v[12:15], v2
    ds_read_b128 v[16:19], v3
    ds_read_b128 v[20:23], v6 offset:0
    ds_read_b128 v[24:27], v7 offset:0
    ds_read_b128 v[28:31], v6 offset:2048
    s_waitcnt lgkmcnt(3)
    v_cndmask_b32 v19, 0, v19, vcc
    v_mov_b32 v69, 1
    ds_read_b128 v[32:35], v7 offset:2048
    s_waitcnt lgkmcnt(3)
    v_mfma_f32_32x32x16_bf16 v[76:91], v[20:23], v[12:15], v[76:91]
    ds_read_b128 v[20:23], v6 offset:4096
    s_waitcnt lgkmcnt(3)
    v_mfma_f32_32x32x16_bf16 v[76:91], v[24:27], v[16:19], v[76:91]
    ds_read_b128 v[24:27], v7 offset:4096
    s_waitcnt lgkmcnt(3)
    v_mfma_f32_32x32x16_bf16 v[92:107], v[28:31], v[12:15], 0
    ds_read_b128 v[28:31], v6 offset:6144
    s_waitcnt lgkmcnt(3)
    v_mfma_f32_32x32x16_bf16 v[92:107], v[32:35], v[16:19], v[92:107]
    ds_read_b128 v[32:35], v7 offset:6144
    s_waitcnt lgkmcnt(3)
    v_mfma_f32_32x32x16_bf16 v[108:123], v[20:23], v[12:15], 0
    ds_read_b128 v[20:23], v6 offset:8192
    s_waitcnt lgkmcnt(3)
    v_mfma_f32_32x32x16_bf16 v[108:123], v[24:27], v[16:19], v[108:123]
    v_max3_f32 v68, v76, v77, v78
    v_max3_f32 v68, v68, v79, v80
    v_max3_f32 v68, v68, v81, v82
    v_max3_f32 v68, v68, v83, v84
    ds_read_b128 v[24:27], v7 offset:8192
    s_waitcnt lgkmcnt(3)
    v_mfma_f32_32x32x16_bf16 v[124:139], v[28:31], v[12:15], 0
    v_max3_f32 v68, v68, v85, v86
    v_max3_f32 v68, v68, v87, v88
    v_max3_f32 v68, v68, v89, v90
    v_max_f32 v68, v68, v91
    ds_read_b128 v[28:31], v6 offset:10240
    s_waitcnt lgkmcnt(3)
    v_mfma_f32_32x32x16_bf16 v[124:139], v[32:35], v[16:19], v[124:139]
    v_max3_f32 v68, v68, v92, v93
    v_max3_f32 v70, v70, v94, v95
    v_max3_f32 v68, v68, v96, v97
    v_max3_f32 v70, v70, v98, v99
    ds_read_b128 v[32:35], v7 offset:10240
    s_waitcnt lgkmcnt(3)
    v_mfma_f32_32x32x16_bf16 v[140:155], v[20:23], v[12:15], 0
    v_max3_f32 v68, v68, v100, v101
    v_max3_f32 v70, v70, v102, v103
    v_max3_f32 v68, v68, v104, v105
    v_max3_f32 v70, v70, v106, v107
    ds_read_b128 v[20:23], v6 offset:12288
    s_waitcnt lgkmcnt(3)
    v_mfma_f32_32x32x16_bf16 v[140:155], v[24:27], v[16:19], v[140:155]
    v_max3_f32 v68, v68, v108, v109
    v_max3_f32 v70, v70, v110, v111
    v_max3_f32 v68, v68, v112, v113
    v_max3_f32 v70, v70, v114, v115
    ds_read_b128 v[24:27], v7 offset:12288
    s_waitcnt lgkmcnt(3)
    v_mfma_f32_32x32x16_bf16 v[156:171], v[28:31], v[12:15], 0
    v_max3_f32 v68, v68, v116, v117
    v_max3_f32 v70, v70, v118, v119
    v_max3_f32 v68, v68, v120, v121
    v_max3_f32 v70, v70, v122, v123
    ds_read_b128 v[28:31], v6 offset:14336
    s_waitcnt lgkmcnt(3)
    v_mfma_f32_32x32x16_bf16 v[156:171], v[32:35], v[16:19], v[156:171]
    v_max3_f32 v68, v68, v124, v125
    v_max3_f32 v70, v70, v126, v127
    v_max3_f32 v68, v68, v128, v129
    v_max3_f32 v70, v70, v130, v131
    ds_read_b128 v[32:35], v7 offset:14336
    s_waitcnt lgkmcnt(3)
    v_mfma_f32_32x32x16_bf16 v[172:187], v[20:23], v[12:15], 0
    v_max3_f32 v68, v68, v132, v133
    v_max3_f32 v70, v70, v134, v135
    v_max3_f32 v68, v68, v136, v137
    v_max3_f32 v70, v70, v138, v139
    ds_read_b128 v[20:23], v6 offset:16384
    s_waitcnt lgkmcnt(3)
    v_mfma_f32_32x32x16_bf16 v[172:187], v[24:27], v[16:19], v[172:187]
    v_max3_f32 v68, v68, v140, v141
    v_max3_f32 v70, v70, v142, v143
    v_max3_f32 v68, v68, v144, v145
    v_max3_f32 v70, v70, v146, v147
    ds_read_b128 v[24:27], v7 offset:16384
    s_waitcnt lgkmcnt(3)
    v_mfma_f32_32x32x16_bf16 v[188:203], v[28:31], v[12:15], 0
    v_max3_f32 v68, v68, v148, v149
    v_max3_f32 v70, v70, v150, v151
    v_max3_f32 v68, v68, v152, v153
    v_max3_f32 v70, v70, v154, v155
    s_waitcnt lgkmcnt(2)
    v_mfma_f32_32x32x16_bf16 v[188:203], v[32:35], v[16:19], v[188:203]
    v_max3_f32 v68, v68, v156, v157
    v_max3_f32 v70, v70, v158, v159
    v_max3_f32 v68, v68, v160, v161
    v_max3_f32 v70, v70, v162, v163
    s_waitcnt lgkmcnt(1)
    v_mfma_f32_32x32x16_bf16 v[204:219], v[20:23], v[12:15], v[204:219]
    v_max3_f32 v68, v68, v164, v165
    v_max3_f32 v70, v70, v166, v167
    v_max3_f32 v68, v68, v168, v169
    v_max3_f32 v70, v70, v170, v171
    s_waitcnt lgkmcnt(0)
    v_mfma_f32_32x32x16_bf16 v[204:219], v[24:27], v[16:19], v[204:219]
    v_max3_f32 v68, v68, v172, v173
    v_max3_f32 v70, v70, v174, v175
    v_max3_f32 v68, v68, v176, v177
    v_max3_f32 v70, v70, v178, v179
    s_mov_b64 exec, 0xf
    ds_add_u32 v10, v69
    s_mov_b64 exec, -1
    v_mov_b32 v4, 163760
    s_nop 7
    v_max3_f32 v68, v68, v180, v181
    v_max3_f32 v70, v70, v182, v183
    v_max3_f32 v68, v68, v184, v185
    v_max3_f32 v70, v70, v186, v187
    v_max3_f32 v68, v68, v188, v189
    v_max3_f32 v70, v70, v190, v191
    v_max3_f32 v68, v68, v192, v193
    v_max3_f32 v70, v70, v194, v195
    v_max3_f32 v68, v68, v196, v197
    v_max3_f32 v70, v70, v198, v199
    v_max3_f32 v68, v68, v200, v201
    v_max3_f32 v70, v70, v202, v203
    v_max3_f32 v68, v68, v204, v205
    v_max3_f32 v70, v70, v206, v207
    v_max3_f32 v68, v68, v208, v209
    v_max3_f32 v70, v70, v210, v211
    v_max3_f32 v68, v68, v212, v213
    v_max3_f32 v70, v70, v214, v215
    v_max3_f32 v68, v68, v216, v217
    v_max3_f32 v70, v70, v218, v219
    s_mov_b32 s62, 0
spin_38:
    ds_read_b32 v5, v4
    s_add_u32 s62, s62, 1
    s_waitcnt lgkmcnt(0)
    v_readfirstlane_b32 s63, v5
    s_cmp_gt_u32 s62, 524288
    s_cbranch_scc1 spin_38_done
    s_cmp_ge_u32 s63, 4
    s_cbranch_scc1 spin_38_done
    s_nop 0
    s_branch spin_38

spin_38_done:
    ds_read_b64_tr_b16 v[36:37], v8 offset:0
    ds_read_b64_tr_b16 v[38:39], v9 offset:0
    ds_read_b64_tr_b16 v[40:41], v8 offset:1024
    ds_read_b64_tr_b16 v[42:43], v9 offset:1024
    ds_read_b64_tr_b16 v[44:45], v8 offset:2048
    ds_read_b64_tr_b16 v[46:47], v9 offset:2048
    v_max_f32 v68, v68, v70
    v_mov_b32 v69, v68
    s_nop 1
    v_permlane32_swap_b32 v68, v69
    s_nop 0
    v_max_f32 v68, v68, v69
    v_mul_f32 v72, s26, v68

    .p2align 3
    v_pk_fma_f32 v[76:77], v[76:77], s[26:27], v[72:73] op_sel_hi:[1,0,0] neg_lo:[0,0,1] neg_hi:[0,0,1]
    v_pk_fma_f32 v[78:79], v[78:79], s[26:27], v[72:73] op_sel_hi:[1,0,0] neg_lo:[0,0,1] neg_hi:[0,0,1]
    v_pk_fma_f32 v[80:81], v[80:81], s[26:27], v[72:73] op_sel_hi:[1,0,0] neg_lo:[0,0,1] neg_hi:[0,0,1]
    v_pk_fma_f32 v[82:83], v[82:83], s[26:27], v[72:73] op_sel_hi:[1,0,0] neg_lo:[0,0,1] neg_hi:[0,0,1]
    v_pk_fma_f32 v[84:85], v[84:85], s[26:27], v[72:73] op_sel_hi:[1,0,0] neg_lo:[0,0,1] neg_hi:[0,0,1]
    v_pk_fma_f32 v[86:87], v[86:87], s[26:27], v[72:73] op_sel_hi:[1,0,0] neg_lo:[0,0,1] neg_hi:[0,0,1]
    v_pk_fma_f32 v[88:89], v[88:89], s[26:27], v[72:73] op_sel_hi:[1,0,0] neg_lo:[0,0,1] neg_hi:[0,0,1]
    v_pk_fma_f32 v[90:91], v[90:91], s[26:27], v[72:73] op_sel_hi:[1,0,0] neg_lo:[0,0,1] neg_hi:[0,0,1]
    v_exp_f32 v76, v76
    v_exp_f32 v77, v77
    v_exp_f32 v78, v78
    v_exp_f32 v79, v79
    v_exp_f32 v80, v80
    v_exp_f32 v81, v81
    v_exp_f32 v82, v82
    v_exp_f32 v83, v83
    v_exp_f32 v84, v84
    v_exp_f32 v85, v85
    v_exp_f32 v86, v86
    v_exp_f32 v87, v87
    v_exp_f32 v88, v88
    v_exp_f32 v89, v89
    v_exp_f32 v90, v90
    v_exp_f32 v91, v91
    v_cvt_pk_bf16_f32 v76, v76, v77
    v_cvt_pk_bf16_f32 v77, v78, v79
    v_cvt_pk_bf16_f32 v78, v80, v81
    v_cvt_pk_bf16_f32 v79, v82, v83
    v_cvt_pk_bf16_f32 v80, v84, v85
    v_cvt_pk_bf16_f32 v81, v86, v87
    v_cvt_pk_bf16_f32 v82, v88, v89
    v_cvt_pk_bf16_f32 v83, v90, v91
    .p2align 3
    v_pk_fma_f32 v[92:93], v[92:93], s[26:27], v[72:73] op_sel_hi:[1,0,0] neg_lo:[0,0,1] neg_hi:[0,0,1]
    v_pk_fma_f32 v[94:95], v[94:95], s[26:27], v[72:73] op_sel_hi:[1,0,0] neg_lo:[0,0,1] neg_hi:[0,0,1]
    v_pk_fma_f32 v[96:97], v[96:97], s[26:27], v[72:73] op_sel_hi:[1,0,0] neg_lo:[0,0,1] neg_hi:[0,0,1]
    v_pk_fma_f32 v[98:99], v[98:99], s[26:27], v[72:73] op_sel_hi:[1,0,0] neg_lo:[0,0,1] neg_hi:[0,0,1]
    v_pk_fma_f32 v[100:101], v[100:101], s[26:27], v[72:73] op_sel_hi:[1,0,0] neg_lo:[0,0,1] neg_hi:[0,0,1]
    v_pk_fma_f32 v[102:103], v[102:103], s[26:27], v[72:73] op_sel_hi:[1,0,0] neg_lo:[0,0,1] neg_hi:[0,0,1]
    v_pk_fma_f32 v[104:105], v[104:105], s[26:27], v[72:73] op_sel_hi:[1,0,0] neg_lo:[0,0,1] neg_hi:[0,0,1]
    v_pk_fma_f32 v[106:107], v[106:107], s[26:27], v[72:73] op_sel_hi:[1,0,0] neg_lo:[0,0,1] neg_hi:[0,0,1]
    v_exp_f32 v92, v92
    v_exp_f32 v93, v93
    v_exp_f32 v94, v94
    v_exp_f32 v95, v95
    v_exp_f32 v96, v96
    v_exp_f32 v97, v97
    v_exp_f32 v98, v98
    v_exp_f32 v99, v99
    s_waitcnt lgkmcnt(4)
    v_mfma_f32_32x32x16_bf16 v[52:67], v[36:39], v[76:79], 0
    ds_read_b64_tr_b16 v[48:49], v8 offset:3072
    ds_read_b64_tr_b16 v[50:51], v9 offset:3072
    v_exp_f32 v100, v100
    v_exp_f32 v101, v101
    v_exp_f32 v102, v102
    v_exp_f32 v103, v103
    v_exp_f32 v104, v104
    v_exp_f32 v105, v105
    v_exp_f32 v106, v106
    v_exp_f32 v107, v107
    s_waitcnt lgkmcnt(4)
    v_mfma_f32_32x32x16_bf16 v[52:67], v[40:43], v[80:83], v[52:67]
    ds_read_b64_tr_b16 v[36:37], v8 offset:4096
    ds_read_b64_tr_b16 v[38:39], v9 offset:4096
    v_cvt_pk_bf16_f32 v92, v92, v93
    v_cvt_pk_bf16_f32 v93, v94, v95
    v_cvt_pk_bf16_f32 v94, v96, v97
    v_cvt_pk_bf16_f32 v95, v98, v99
    v_cvt_pk_bf16_f32 v96, v100, v101
    v_cvt_pk_bf16_f32 v97, v102, v103
    v_cvt_pk_bf16_f32 v98, v104, v105
    v_cvt_pk_bf16_f32 v99, v106, v107
    .p2align 3
    v_pk_fma_f32 v[108:109], v[108:109], s[26:27], v[72:73] op_sel_hi:[1,0,0] neg_lo:[0,0,1] neg_hi:[0,0,1]
    v_pk_fma_f32 v[110:111], v[110:111], s[26:27], v[72:73] op_sel_hi:[1,0,0] neg_lo:[0,0,1] neg_hi:[0,0,1]
    v_pk_fma_f32 v[112:113], v[112:113], s[26:27], v[72:73] op_sel_hi:[1,0,0] neg_lo:[0,0,1] neg_hi:[0,0,1]
    v_pk_fma_f32 v[114:115], v[114:115], s[26:27], v[72:73] op_sel_hi:[1,0,0] neg_lo:[0,0,1] neg_hi:[0,0,1]
    v_pk_fma_f32 v[116:117], v[116:117], s[26:27], v[72:73] op_sel_hi:[1,0,0] neg_lo:[0,0,1] neg_hi:[0,0,1]
    v_pk_fma_f32 v[118:119], v[118:119], s[26:27], v[72:73] op_sel_hi:[1,0,0] neg_lo:[0,0,1] neg_hi:[0,0,1]
    v_pk_fma_f32 v[120:121], v[120:121], s[26:27], v[72:73] op_sel_hi:[1,0,0] neg_lo:[0,0,1] neg_hi:[0,0,1]
    v_pk_fma_f32 v[122:123], v[122:123], s[26:27], v[72:73] op_sel_hi:[1,0,0] neg_lo:[0,0,1] neg_hi:[0,0,1]
    v_exp_f32 v108, v108
    v_exp_f32 v109, v109
    v_exp_f32 v110, v110
    v_exp_f32 v111, v111
    v_exp_f32 v112, v112
    v_exp_f32 v113, v113
    v_exp_f32 v114, v114
    v_exp_f32 v115, v115
    s_waitcnt lgkmcnt(4)
    v_mfma_f32_32x32x16_bf16 v[52:67], v[44:47], v[92:95], v[52:67]
    ds_read_b64_tr_b16 v[40:41], v8 offset:5120
    ds_read_b64_tr_b16 v[42:43], v9 offset:5120
    v_exp_f32 v116, v116
    v_exp_f32 v117, v117
    v_exp_f32 v118, v118
    v_exp_f32 v119, v119
    v_exp_f32 v120, v120
    v_exp_f32 v121, v121
    v_exp_f32 v122, v122
    v_exp_f32 v123, v123
    s_waitcnt lgkmcnt(4)
    v_mfma_f32_32x32x16_bf16 v[52:67], v[48:51], v[96:99], v[52:67]
    ds_read_b64_tr_b16 v[44:45], v8 offset:6144
    ds_read_b64_tr_b16 v[46:47], v9 offset:6144
    v_cvt_pk_bf16_f32 v108, v108, v109
    v_cvt_pk_bf16_f32 v109, v110, v111
    v_cvt_pk_bf16_f32 v110, v112, v113
    v_cvt_pk_bf16_f32 v111, v114, v115
    v_cvt_pk_bf16_f32 v112, v116, v117
    v_cvt_pk_bf16_f32 v113, v118, v119
    v_cvt_pk_bf16_f32 v114, v120, v121
    v_cvt_pk_bf16_f32 v115, v122, v123
    .p2align 3
    v_pk_fma_f32 v[124:125], v[124:125], s[26:27], v[72:73] op_sel_hi:[1,0,0] neg_lo:[0,0,1] neg_hi:[0,0,1]
    v_pk_fma_f32 v[126:127], v[126:127], s[26:27], v[72:73] op_sel_hi:[1,0,0] neg_lo:[0,0,1] neg_hi:[0,0,1]
    v_pk_fma_f32 v[128:129], v[128:129], s[26:27], v[72:73] op_sel_hi:[1,0,0] neg_lo:[0,0,1] neg_hi:[0,0,1]
    v_pk_fma_f32 v[130:131], v[130:131], s[26:27], v[72:73] op_sel_hi:[1,0,0] neg_lo:[0,0,1] neg_hi:[0,0,1]
    v_pk_fma_f32 v[132:133], v[132:133], s[26:27], v[72:73] op_sel_hi:[1,0,0] neg_lo:[0,0,1] neg_hi:[0,0,1]
    v_pk_fma_f32 v[134:135], v[134:135], s[26:27], v[72:73] op_sel_hi:[1,0,0] neg_lo:[0,0,1] neg_hi:[0,0,1]
    v_pk_fma_f32 v[136:137], v[136:137], s[26:27], v[72:73] op_sel_hi:[1,0,0] neg_lo:[0,0,1] neg_hi:[0,0,1]
    v_pk_fma_f32 v[138:139], v[138:139], s[26:27], v[72:73] op_sel_hi:[1,0,0] neg_lo:[0,0,1] neg_hi:[0,0,1]
    v_exp_f32 v124, v124
    v_exp_f32 v125, v125
    v_exp_f32 v126, v126
    v_exp_f32 v127, v127
    v_exp_f32 v128, v128
    v_exp_f32 v129, v129
    v_exp_f32 v130, v130
    v_exp_f32 v131, v131
    s_waitcnt lgkmcnt(4)
    v_mfma_f32_32x32x16_bf16 v[52:67], v[36:39], v[108:111], v[52:67]
    ds_read_b64_tr_b16 v[48:49], v8 offset:7168
    ds_read_b64_tr_b16 v[50:51], v9 offset:7168
    v_exp_f32 v132, v132
    v_exp_f32 v133, v133
    v_exp_f32 v134, v134
    v_exp_f32 v135, v135
    v_exp_f32 v136, v136
    v_exp_f32 v137, v137
    v_exp_f32 v138, v138
    v_exp_f32 v139, v139
    s_waitcnt lgkmcnt(4)
    v_mfma_f32_32x32x16_bf16 v[52:67], v[40:43], v[112:115], v[52:67]
    ds_read_b64_tr_b16 v[36:37], v8 offset:8192
    ds_read_b64_tr_b16 v[38:39], v9 offset:8192
    v_cvt_pk_bf16_f32 v124, v124, v125
    v_cvt_pk_bf16_f32 v125, v126, v127
    v_cvt_pk_bf16_f32 v126, v128, v129
    v_cvt_pk_bf16_f32 v127, v130, v131
    v_cvt_pk_bf16_f32 v128, v132, v133
    v_cvt_pk_bf16_f32 v129, v134, v135
    v_cvt_pk_bf16_f32 v130, v136, v137
    v_cvt_pk_bf16_f32 v131, v138, v139
    .p2align 3
    v_pk_fma_f32 v[140:141], v[140:141], s[26:27], v[72:73] op_sel_hi:[1,0,0] neg_lo:[0,0,1] neg_hi:[0,0,1]
    v_pk_fma_f32 v[142:143], v[142:143], s[26:27], v[72:73] op_sel_hi:[1,0,0] neg_lo:[0,0,1] neg_hi:[0,0,1]
    v_pk_fma_f32 v[144:145], v[144:145], s[26:27], v[72:73] op_sel_hi:[1,0,0] neg_lo:[0,0,1] neg_hi:[0,0,1]
    v_pk_fma_f32 v[146:147], v[146:147], s[26:27], v[72:73] op_sel_hi:[1,0,0] neg_lo:[0,0,1] neg_hi:[0,0,1]
    v_pk_fma_f32 v[148:149], v[148:149], s[26:27], v[72:73] op_sel_hi:[1,0,0] neg_lo:[0,0,1] neg_hi:[0,0,1]
    v_pk_fma_f32 v[150:151], v[150:151], s[26:27], v[72:73] op_sel_hi:[1,0,0] neg_lo:[0,0,1] neg_hi:[0,0,1]
    v_pk_fma_f32 v[152:153], v[152:153], s[26:27], v[72:73] op_sel_hi:[1,0,0] neg_lo:[0,0,1] neg_hi:[0,0,1]
    v_pk_fma_f32 v[154:155], v[154:155], s[26:27], v[72:73] op_sel_hi:[1,0,0] neg_lo:[0,0,1] neg_hi:[0,0,1]
    v_exp_f32 v140, v140
    v_exp_f32 v141, v141
    v_exp_f32 v142, v142
    v_exp_f32 v143, v143
    v_exp_f32 v144, v144
    v_exp_f32 v145, v145
    v_exp_f32 v146, v146
    v_exp_f32 v147, v147
    s_waitcnt lgkmcnt(4)
    v_mfma_f32_32x32x16_bf16 v[52:67], v[44:47], v[124:127], v[52:67]
    ds_read_b64_tr_b16 v[40:41], v8 offset:9216
    ds_read_b64_tr_b16 v[42:43], v9 offset:9216
    v_exp_f32 v148, v148
    v_exp_f32 v149, v149
    v_exp_f32 v150, v150
    v_exp_f32 v151, v151
    v_exp_f32 v152, v152
    v_exp_f32 v153, v153
    v_exp_f32 v154, v154
    v_exp_f32 v155, v155
    s_waitcnt lgkmcnt(4)
    v_mfma_f32_32x32x16_bf16 v[52:67], v[48:51], v[128:131], v[52:67]
    ds_read_b64_tr_b16 v[44:45], v8 offset:10240
    ds_read_b64_tr_b16 v[46:47], v9 offset:10240
    v_cvt_pk_bf16_f32 v140, v140, v141
    v_cvt_pk_bf16_f32 v141, v142, v143
    v_cvt_pk_bf16_f32 v142, v144, v145
    v_cvt_pk_bf16_f32 v143, v146, v147
    v_cvt_pk_bf16_f32 v144, v148, v149
    v_cvt_pk_bf16_f32 v145, v150, v151
    v_cvt_pk_bf16_f32 v146, v152, v153
    v_cvt_pk_bf16_f32 v147, v154, v155
    .p2align 3
    v_pk_fma_f32 v[156:157], v[156:157], s[26:27], v[72:73] op_sel_hi:[1,0,0] neg_lo:[0,0,1] neg_hi:[0,0,1]
    v_pk_fma_f32 v[158:159], v[158:159], s[26:27], v[72:73] op_sel_hi:[1,0,0] neg_lo:[0,0,1] neg_hi:[0,0,1]
    v_pk_fma_f32 v[160:161], v[160:161], s[26:27], v[72:73] op_sel_hi:[1,0,0] neg_lo:[0,0,1] neg_hi:[0,0,1]
    v_pk_fma_f32 v[162:163], v[162:163], s[26:27], v[72:73] op_sel_hi:[1,0,0] neg_lo:[0,0,1] neg_hi:[0,0,1]
    v_pk_fma_f32 v[164:165], v[164:165], s[26:27], v[72:73] op_sel_hi:[1,0,0] neg_lo:[0,0,1] neg_hi:[0,0,1]
    v_pk_fma_f32 v[166:167], v[166:167], s[26:27], v[72:73] op_sel_hi:[1,0,0] neg_lo:[0,0,1] neg_hi:[0,0,1]
    v_pk_fma_f32 v[168:169], v[168:169], s[26:27], v[72:73] op_sel_hi:[1,0,0] neg_lo:[0,0,1] neg_hi:[0,0,1]
    v_pk_fma_f32 v[170:171], v[170:171], s[26:27], v[72:73] op_sel_hi:[1,0,0] neg_lo:[0,0,1] neg_hi:[0,0,1]
    v_exp_f32 v156, v156
    v_exp_f32 v157, v157
    v_exp_f32 v158, v158
    v_exp_f32 v159, v159
    v_exp_f32 v160, v160
    v_exp_f32 v161, v161
    v_exp_f32 v162, v162
    v_exp_f32 v163, v163
    s_waitcnt lgkmcnt(4)
    v_mfma_f32_32x32x16_bf16 v[52:67], v[36:39], v[140:143], v[52:67]
    ds_read_b64_tr_b16 v[48:49], v8 offset:11264
    ds_read_b64_tr_b16 v[50:51], v9 offset:11264
    v_exp_f32 v164, v164
    v_exp_f32 v165, v165
    v_exp_f32 v166, v166
    v_exp_f32 v167, v167
    v_exp_f32 v168, v168
    v_exp_f32 v169, v169
    v_exp_f32 v170, v170
    v_exp_f32 v171, v171
    s_waitcnt lgkmcnt(4)
    v_mfma_f32_32x32x16_bf16 v[52:67], v[40:43], v[144:147], v[52:67]
    ds_read_b64_tr_b16 v[36:37], v8 offset:12288
    ds_read_b64_tr_b16 v[38:39], v9 offset:12288
    v_cvt_pk_bf16_f32 v156, v156, v157
    v_cvt_pk_bf16_f32 v157, v158, v159
    v_cvt_pk_bf16_f32 v158, v160, v161
    v_cvt_pk_bf16_f32 v159, v162, v163
    v_cvt_pk_bf16_f32 v160, v164, v165
    v_cvt_pk_bf16_f32 v161, v166, v167
    v_cvt_pk_bf16_f32 v162, v168, v169
    v_cvt_pk_bf16_f32 v163, v170, v171
    .p2align 3
    v_pk_fma_f32 v[172:173], v[172:173], s[26:27], v[72:73] op_sel_hi:[1,0,0] neg_lo:[0,0,1] neg_hi:[0,0,1]
    v_pk_fma_f32 v[174:175], v[174:175], s[26:27], v[72:73] op_sel_hi:[1,0,0] neg_lo:[0,0,1] neg_hi:[0,0,1]
    v_pk_fma_f32 v[176:177], v[176:177], s[26:27], v[72:73] op_sel_hi:[1,0,0] neg_lo:[0,0,1] neg_hi:[0,0,1]
    v_pk_fma_f32 v[178:179], v[178:179], s[26:27], v[72:73] op_sel_hi:[1,0,0] neg_lo:[0,0,1] neg_hi:[0,0,1]
    v_pk_fma_f32 v[180:181], v[180:181], s[26:27], v[72:73] op_sel_hi:[1,0,0] neg_lo:[0,0,1] neg_hi:[0,0,1]
    v_pk_fma_f32 v[182:183], v[182:183], s[26:27], v[72:73] op_sel_hi:[1,0,0] neg_lo:[0,0,1] neg_hi:[0,0,1]
    v_pk_fma_f32 v[184:185], v[184:185], s[26:27], v[72:73] op_sel_hi:[1,0,0] neg_lo:[0,0,1] neg_hi:[0,0,1]
    v_pk_fma_f32 v[186:187], v[186:187], s[26:27], v[72:73] op_sel_hi:[1,0,0] neg_lo:[0,0,1] neg_hi:[0,0,1]
    v_exp_f32 v172, v172
    v_exp_f32 v173, v173
    v_exp_f32 v174, v174
    v_exp_f32 v175, v175
    v_exp_f32 v176, v176
    v_exp_f32 v177, v177
    v_exp_f32 v178, v178
    v_exp_f32 v179, v179
    s_waitcnt lgkmcnt(4)
    v_mfma_f32_32x32x16_bf16 v[52:67], v[44:47], v[156:159], v[52:67]
    ds_read_b64_tr_b16 v[40:41], v8 offset:13312
    ds_read_b64_tr_b16 v[42:43], v9 offset:13312
    v_exp_f32 v180, v180
    v_exp_f32 v181, v181
    v_exp_f32 v182, v182
    v_exp_f32 v183, v183
    v_exp_f32 v184, v184
    v_exp_f32 v185, v185
    v_exp_f32 v186, v186
    v_exp_f32 v187, v187
    s_waitcnt lgkmcnt(4)
    v_mfma_f32_32x32x16_bf16 v[52:67], v[48:51], v[160:163], v[52:67]
    ds_read_b64_tr_b16 v[44:45], v8 offset:14336
    ds_read_b64_tr_b16 v[46:47], v9 offset:14336
    v_cvt_pk_bf16_f32 v172, v172, v173
    v_cvt_pk_bf16_f32 v173, v174, v175
    v_cvt_pk_bf16_f32 v174, v176, v177
    v_cvt_pk_bf16_f32 v175, v178, v179
    v_cvt_pk_bf16_f32 v176, v180, v181
    v_cvt_pk_bf16_f32 v177, v182, v183
    v_cvt_pk_bf16_f32 v178, v184, v185
    v_cvt_pk_bf16_f32 v179, v186, v187
    .p2align 3
    v_pk_fma_f32 v[188:189], v[188:189], s[26:27], v[72:73] op_sel_hi:[1,0,0] neg_lo:[0,0,1] neg_hi:[0,0,1]
    v_pk_fma_f32 v[190:191], v[190:191], s[26:27], v[72:73] op_sel_hi:[1,0,0] neg_lo:[0,0,1] neg_hi:[0,0,1]
    v_pk_fma_f32 v[192:193], v[192:193], s[26:27], v[72:73] op_sel_hi:[1,0,0] neg_lo:[0,0,1] neg_hi:[0,0,1]
    v_pk_fma_f32 v[194:195], v[194:195], s[26:27], v[72:73] op_sel_hi:[1,0,0] neg_lo:[0,0,1] neg_hi:[0,0,1]
    v_pk_fma_f32 v[196:197], v[196:197], s[26:27], v[72:73] op_sel_hi:[1,0,0] neg_lo:[0,0,1] neg_hi:[0,0,1]
    v_pk_fma_f32 v[198:199], v[198:199], s[26:27], v[72:73] op_sel_hi:[1,0,0] neg_lo:[0,0,1] neg_hi:[0,0,1]
    v_pk_fma_f32 v[200:201], v[200:201], s[26:27], v[72:73] op_sel_hi:[1,0,0] neg_lo:[0,0,1] neg_hi:[0,0,1]
    v_pk_fma_f32 v[202:203], v[202:203], s[26:27], v[72:73] op_sel_hi:[1,0,0] neg_lo:[0,0,1] neg_hi:[0,0,1]
    v_exp_f32 v188, v188
    v_exp_f32 v189, v189
    v_exp_f32 v190, v190
    v_exp_f32 v191, v191
    v_exp_f32 v192, v192
    v_exp_f32 v193, v193
    v_exp_f32 v194, v194
    v_exp_f32 v195, v195
    s_waitcnt lgkmcnt(4)
    v_mfma_f32_32x32x16_bf16 v[52:67], v[36:39], v[172:175], v[52:67]
    ds_read_b64_tr_b16 v[48:49], v8 offset:15360
    ds_read_b64_tr_b16 v[50:51], v9 offset:15360
    v_exp_f32 v196, v196
    v_exp_f32 v197, v197
    v_exp_f32 v198, v198
    v_exp_f32 v199, v199
    v_exp_f32 v200, v200
    v_exp_f32 v201, v201
    v_exp_f32 v202, v202
    v_exp_f32 v203, v203
    s_waitcnt lgkmcnt(4)
    v_mfma_f32_32x32x16_bf16 v[52:67], v[40:43], v[176:179], v[52:67]
    ds_read_b64_tr_b16 v[36:37], v8 offset:16384
    ds_read_b64_tr_b16 v[38:39], v9 offset:16384
    v_cvt_pk_bf16_f32 v188, v188, v189
    v_cvt_pk_bf16_f32 v189, v190, v191
    v_cvt_pk_bf16_f32 v190, v192, v193
    v_cvt_pk_bf16_f32 v191, v194, v195
    v_cvt_pk_bf16_f32 v192, v196, v197
    v_cvt_pk_bf16_f32 v193, v198, v199
    v_cvt_pk_bf16_f32 v194, v200, v201
    v_cvt_pk_bf16_f32 v195, v202, v203
    .p2align 3
    v_pk_fma_f32 v[204:205], v[204:205], s[26:27], v[72:73] op_sel_hi:[1,0,0] neg_lo:[0,0,1] neg_hi:[0,0,1]
    v_pk_fma_f32 v[206:207], v[206:207], s[26:27], v[72:73] op_sel_hi:[1,0,0] neg_lo:[0,0,1] neg_hi:[0,0,1]
    v_pk_fma_f32 v[208:209], v[208:209], s[26:27], v[72:73] op_sel_hi:[1,0,0] neg_lo:[0,0,1] neg_hi:[0,0,1]
    v_pk_fma_f32 v[210:211], v[210:211], s[26:27], v[72:73] op_sel_hi:[1,0,0] neg_lo:[0,0,1] neg_hi:[0,0,1]
    v_pk_fma_f32 v[212:213], v[212:213], s[26:27], v[72:73] op_sel_hi:[1,0,0] neg_lo:[0,0,1] neg_hi:[0,0,1]
    v_pk_fma_f32 v[214:215], v[214:215], s[26:27], v[72:73] op_sel_hi:[1,0,0] neg_lo:[0,0,1] neg_hi:[0,0,1]
    v_pk_fma_f32 v[216:217], v[216:217], s[26:27], v[72:73] op_sel_hi:[1,0,0] neg_lo:[0,0,1] neg_hi:[0,0,1]
    v_pk_fma_f32 v[218:219], v[218:219], s[26:27], v[72:73] op_sel_hi:[1,0,0] neg_lo:[0,0,1] neg_hi:[0,0,1]
    v_exp_f32 v204, v204
    v_exp_f32 v205, v205
    v_exp_f32 v206, v206
    v_exp_f32 v207, v207
    v_exp_f32 v208, v208
    v_exp_f32 v209, v209
    v_exp_f32 v210, v210
    v_exp_f32 v211, v211
    s_waitcnt lgkmcnt(4)
    v_mfma_f32_32x32x16_bf16 v[52:67], v[44:47], v[188:191], v[52:67]
    ds_read_b64_tr_b16 v[40:41], v8 offset:17408
    ds_read_b64_tr_b16 v[42:43], v9 offset:17408
    v_exp_f32 v212, v212
    v_exp_f32 v213, v213
    v_exp_f32 v214, v214
    v_exp_f32 v215, v215
    v_exp_f32 v216, v216
    v_exp_f32 v217, v217
    v_exp_f32 v218, v218
    v_exp_f32 v219, v219
    s_waitcnt lgkmcnt(4)
    v_mfma_f32_32x32x16_bf16 v[52:67], v[48:51], v[192:195], v[52:67]
    v_cvt_pk_bf16_f32 v204, v204, v205
    v_cvt_pk_bf16_f32 v205, v206, v207
    v_cvt_pk_bf16_f32 v206, v208, v209
    v_cvt_pk_bf16_f32 v207, v210, v211
    v_cvt_pk_bf16_f32 v208, v212, v213
    v_cvt_pk_bf16_f32 v209, v214, v215
    v_cvt_pk_bf16_f32 v210, v216, v217
    v_cvt_pk_bf16_f32 v211, v218, v219
    s_nop 1
    s_waitcnt lgkmcnt(2)
    v_mfma_f32_32x32x16_bf16 v[52:67], v[36:39], v[204:207], v[52:67]
    s_waitcnt lgkmcnt(0)
    v_mfma_f32_32x32x16_bf16 v[52:67], v[40:43], v[208:211], v[52:67]
    v_mov_b32 v4, 163712
    s_mov_b32 s62, 0
spin_39:
    ds_read_b32 v5, v4
    s_add_u32 s62, s62, 1
    s_waitcnt lgkmcnt(0)
    v_readfirstlane_b32 s63, v5
    s_cmp_gt_u32 s62, 524288
    s_cbranch_scc1 spin_39_done
    s_cmp_ge_u32 s63, 4
    s_cbranch_scc1 spin_39_done
    s_nop 0
    s_branch spin_39

spin_39_done:
    s_nop 7
    v_mov_b32 v69, v64
    v_mov_b32 v70, v64
    s_nop 1
    v_permlane32_swap_b32 v69, v70
    v_cmp_gt_u32 vcc, 32, v1
    v_rcp_f32 v70, v70
    v_mov_b32 v69, s3

    v_mul_f32 v52, v52, v70
    v_mul_f32 v53, v53, v70
    v_mul_f32 v54, v54, v70
    v_mul_f32 v55, v55, v70
    v_mul_f32 v56, v56, v70
    v_mul_f32 v57, v57, v70
    v_mul_f32 v58, v58, v70
    v_mul_f32 v59, v59, v70
    v_mul_f32 v60, v60, v70
    v_mul_f32 v61, v61, v70
    v_mul_f32 v62, v62, v70
    v_mul_f32 v63, v63, v70
    v_mul_f32 v64, v64, v70
    v_mul_f32 v65, v65, v70
    v_mul_f32 v66, v66, v70
    v_mul_f32 v67, v67, v70
    v_cvt_pk_bf16_f32 v52, v52, v53
    v_cvt_pk_bf16_f32 v53, v54, v55
    v_cvt_pk_bf16_f32 v54, v56, v57
    v_cvt_pk_bf16_f32 v55, v58, v59
    v_cvt_pk_bf16_f32 v56, v60, v61
    v_cvt_pk_bf16_f32 v57, v62, v63
    v_cvt_pk_bf16_f32 v58, v64, v65
    v_cvt_pk_bf16_f32 v59, v66, v67
    v_cndmask_b32 v58, 0, v58, vcc
    v_cndmask_b32 v59, v69, v59, vcc

    v_xor_b32 v2, 0, v74
    ds_write_b64 v2, v[52:53]
    v_xor_b32 v2, 16, v74
    ds_write_b64 v2, v[54:55]
    v_xor_b32 v2, 32, v74
    ds_write_b64 v2, v[56:57]
    v_xor_b32 v2, 48, v74
    ds_write_b64 v2, v[58:59]
    s_lshl_b32 s23, s56, 11
    s_add_u32 s24, s23, 16384
    v_add_u32 v3, s24, v75
    s_waitcnt lgkmcnt(0)
    ds_read_b128 v[52:55], v3
    ds_read_b128 v[56:59], v3 offset:1024
    s_lshl_b32 s24, s22, 13
    s_add_u32 s23, s23, s24
    s_add_u32 s24, s23, 1024
    s_waitcnt lgkmcnt(1)
    buffer_store_dwordx4 v[52:55], v75, s[40:43], s23 offen sc1
    s_waitcnt lgkmcnt(0)
    buffer_store_dwordx4 v[56:59], v75, s[40:43], s24 offen sc1

    s_cmp_ge_u32 s58, 28
    s_cbranch_scc1 K_FIN
P3_START:
    s_lshl_b32 s34, s59, 10
    v_add_u32 v5, 107520, v228
    s_waitcnt lgkmcnt(0)
    s_barrier
    s_cmp_eq_u32 s55, 1
    s_cbranch_scc1 P3_loader_40
    ds_read_b128 v[76:79], v228 offset:0
    ds_read_b128 v[80:83], v228 offset:4096
    ds_read_b128 v[84:87], v228 offset:8192
    ds_read_b128 v[88:91], v228 offset:12288
    ds_read_b128 v[92:95], v5 offset:0
    ds_read_b128 v[96:99], v5 offset:4096
    ds_read_b128 v[100:103], v5 offset:8192
    ds_read_b128 v[104:107], v5 offset:12288
    global_load_dwordx2 v[30:31], v233, s[82:83] sc1
    v_cmp_gt_u32 vcc, 48, v1
    s_waitcnt lgkmcnt(0)
    v_cndmask_b32 v79, 0, v79, vcc
    v_cndmask_b32 v83, 0, v83, vcc
    v_cndmask_b32 v87, 0, v87, vcc
    v_cndmask_b32 v91, 0, v91, vcc
    v_cndmask_b32 v95, 0, v95, vcc
    v_cndmask_b32 v99, 0, v99, vcc
    v_cndmask_b32 v103, 0, v103, vcc
    v_cndmask_b32 v107, 0, v107, vcc
    ds_read_b64_tr_b16 v[32:33], v229 offset:0
    ds_read_b64_tr_b16 v[34:35], v229 offset:2048
    ds_read_b64_tr_b16 v[36:37], v230 offset:0
    ds_read_b64_tr_b16 v[38:39], v230 offset:2048
    ds_read_b64_tr_b16 v[40:41], v231 offset:0
    ds_read_b64_tr_b16 v[42:43], v231 offset:2048
    ds_read_b64_tr_b16 v[44:45], v232 offset:0
    ds_read_b64_tr_b16 v[46:47], v232 offset:2048
    ds_read_b64_tr_b16 v[48:49], v229 offset:3584
    ds_read_b64_tr_b16 v[50:51], v229 offset:5632
    s_waitcnt lgkmcnt(6)
    ds_read_b64_tr_b16 v[52:53], v230 offset:3584
    v_mfma_f32_16x16x32_bf16 v[56:59], v[32:35], v[76:79], 0
    ds_read_b64_tr_b16 v[54:55], v230 offset:5632
    ds_read_b64_tr_b16 v[32:33], v231 offset:3584
    v_mfma_f32_16x16x32_bf16 v[60:63], v[36:39], v[76:79], 0
    ds_read_b64_tr_b16 v[34:35], v231 offset:5632
    s_waitcnt lgkmcnt(6)
    ds_read_b64_tr_b16 v[36:37], v232 offset:3584
    v_mfma_f32_16x16x32_bf16 v[64:67], v[40:43], v[76:79], 0
    ds_read_b64_tr_b16 v[38:39], v232 offset:5632
    ds_read_b64_tr_b16 v[40:41], v229 offset:7168
    v_mfma_f32_16x16x32_bf16 v[68:71], v[44:47], v[76:79], 0
    ds_read_b64_tr_b16 v[42:43], v229 offset:9216
    s_waitcnt lgkmcnt(6)
    ds_read_b64_tr_b16 v[44:45], v230 offset:7168
    v_mfma_f32_16x16x32_bf16 v[56:59], v[48:51], v[80:83], v[56:59]
    ds_read_b64_tr_b16 v[46:47], v230 offset:9216
    ds_read_b64_tr_b16 v[48:49], v231 offset:7168
    v_mfma_f32_16x16x32_bf16 v[60:63], v[52:55], v[80:83], v[60:63]
    ds_read_b64_tr_b16 v[50:51], v231 offset:9216
    s_waitcnt lgkmcnt(6)
    ds_read_b64_tr_b16 v[52:53], v232 offset:7168
    v_mfma_f32_16x16x32_bf16 v[64:67], v[32:35], v[80:83], v[64:67]
    ds_read_b64_tr_b16 v[54:55], v232 offset:9216
    ds_read_b64_tr_b16 v[32:33], v229 offset:10752
    v_mfma_f32_16x16x32_bf16 v[68:71], v[36:39], v[80:83], v[68:71]
    ds_read_b64_tr_b16 v[34:35], v229 offset:12800
    s_waitcnt lgkmcnt(6)
    ds_read_b64_tr_b16 v[36:37], v230 offset:10752
    v_mfma_f32_16x16x32_bf16 v[56:59], v[40:43], v[84:87], v[56:59]
    ds_read_b64_tr_b16 v[38:39], v230 offset:12800
    ds_read_b64_tr_b16 v[40:41], v231 offset:10752
    v_mfma_f32_16x16x32_bf16 v[60:63], v[44:47], v[84:87], v[60:63]
    ds_read_b64_tr_b16 v[42:43], v231 offset:12800
    s_waitcnt lgkmcnt(6)
    ds_read_b64_tr_b16 v[44:45], v232 offset:10752
    v_mfma_f32_16x16x32_bf16 v[64:67], v[48:51], v[84:87], v[64:67]
    ds_read_b64_tr_b16 v[46:47], v232 offset:12800
    ds_read_b64_tr_b16 v[48:49], v229 offset:14336
    v_mfma_f32_16x16x32_bf16 v[68:71], v[52:55], v[84:87], v[68:71]
    ds_read_b64_tr_b16 v[50:51], v229 offset:16384
    s_waitcnt lgkmcnt(6)
    ds_read_b64_tr_b16 v[52:53], v230 offset:14336
    v_mfma_f32_16x16x32_bf16 v[56:59], v[32:35], v[88:91], v[56:59]
    ds_read_b64_tr_b16 v[54:55], v230 offset:16384
    ds_read_b64_tr_b16 v[32:33], v231 offset:14336
    v_mfma_f32_16x16x32_bf16 v[60:63], v[36:39], v[88:91], v[60:63]
    ds_read_b64_tr_b16 v[34:35], v231 offset:16384
    s_waitcnt lgkmcnt(6)
    ds_read_b64_tr_b16 v[36:37], v232 offset:14336
    v_mfma_f32_16x16x32_bf16 v[64:67], v[40:43], v[88:91], v[64:67]
    ds_read_b64_tr_b16 v[38:39], v232 offset:16384
    ds_read_b64_tr_b16 v[40:41], v229 offset:17920
    v_mfma_f32_16x16x32_bf16 v[68:71], v[44:47], v[88:91], v[68:71]
    ds_read_b64_tr_b16 v[42:43], v229 offset:19968
    s_waitcnt lgkmcnt(6)
    ds_read_b64_tr_b16 v[44:45], v230 offset:17920
    v_mfma_f32_16x16x32_bf16 v[56:59], v[48:51], v[92:95], v[56:59]
    ds_read_b64_tr_b16 v[46:47], v230 offset:19968
    ds_read_b64_tr_b16 v[48:49], v231 offset:17920
    v_mfma_f32_16x16x32_bf16 v[60:63], v[52:55], v[92:95], v[60:63]
    ds_read_b64_tr_b16 v[50:51], v231 offset:19968
    s_waitcnt lgkmcnt(6)
    ds_read_b64_tr_b16 v[52:53], v232 offset:17920
    v_mfma_f32_16x16x32_bf16 v[64:67], v[32:35], v[92:95], v[64:67]
    ds_read_b64_tr_b16 v[54:55], v232 offset:19968
    ds_read_b64_tr_b16 v[32:33], v229 offset:21504
    v_mfma_f32_16x16x32_bf16 v[68:71], v[36:39], v[92:95], v[68:71]
    ds_read_b64_tr_b16 v[34:35], v229 offset:23552
    s_waitcnt lgkmcnt(6)
    ds_read_b64_tr_b16 v[36:37], v230 offset:21504
    v_mfma_f32_16x16x32_bf16 v[56:59], v[40:43], v[96:99], v[56:59]
    ds_read_b64_tr_b16 v[38:39], v230 offset:23552
    ds_read_b64_tr_b16 v[40:41], v231 offset:21504
    v_mfma_f32_16x16x32_bf16 v[60:63], v[44:47], v[96:99], v[60:63]
    ds_read_b64_tr_b16 v[42:43], v231 offset:23552
    s_waitcnt lgkmcnt(6)
    ds_read_b64_tr_b16 v[44:45], v232 offset:21504
    v_mfma_f32_16x16x32_bf16 v[64:67], v[48:51], v[96:99], v[64:67]
    ds_read_b64_tr_b16 v[46:47], v232 offset:23552
    ds_read_b64_tr_b16 v[48:49], v229 offset:25088
    v_mfma_f32_16x16x32_bf16 v[68:71], v[52:55], v[96:99], v[68:71]
    ds_read_b64_tr_b16 v[50:51], v229 offset:27136
    s_waitcnt lgkmcnt(6)
    ds_read_b64_tr_b16 v[52:53], v230 offset:25088
    v_mfma_f32_16x16x32_bf16 v[56:59], v[32:35], v[100:103], v[56:59]
    ds_read_b64_tr_b16 v[54:55], v230 offset:27136
    ds_read_b64_tr_b16 v[32:33], v231 offset:25088
    v_mfma_f32_16x16x32_bf16 v[60:63], v[36:39], v[100:103], v[60:63]
    ds_read_b64_tr_b16 v[34:35], v231 offset:27136
    s_waitcnt lgkmcnt(6)
    ds_read_b64_tr_b16 v[36:37], v232 offset:25088
    v_mfma_f32_16x16x32_bf16 v[64:67], v[40:43], v[100:103], v[64:67]
    ds_read_b64_tr_b16 v[38:39], v232 offset:27136
    v_mfma_f32_16x16x32_bf16 v[68:71], v[44:47], v[100:103], v[68:71]
    s_waitcnt lgkmcnt(4)
    v_mfma_f32_16x16x32_bf16 v[56:59], v[48:51], v[104:107], v[56:59]
    v_mfma_f32_16x16x32_bf16 v[60:63], v[52:55], v[104:107], v[60:63]
    s_waitcnt lgkmcnt(0)
    v_mfma_f32_16x16x32_bf16 v[64:67], v[32:35], v[104:107], v[64:67]
    v_mfma_f32_16x16x32_bf16 v[68:71], v[36:39], v[104:107], v[68:71]
    s_cmp_lg_u32 s56, 0
    s_cbranch_scc1 P3_loader_40_j
    s_mov_b64 exec, 0xffff
    s_mov_b32 s62, 0
poll_42:
    global_load_dword v2, v237, s[82:83] sc1
    s_add_u32 s62, s62, 1
    s_waitcnt vmcnt(0)
    v_cmp_ne_u32 vcc, s3, v2
    s_cmp_gt_u32 s62, 65536
    s_cbranch_scc1 poll_42_done
    s_cbranch_vccz poll_42_done
    s_sleep 3
    s_branch poll_42

poll_42_done:
    s_mov_b64 exec, -1
    s_branch P3_loader_40_j
P3_loader_40:
    s_cmp_eq_u32 s59, 3
    s_cselect_b32 exec_hi, 0, -1
    s_add_u32 m0, s34, 16384
    s_mov_b32 s32, 0
    buffer_load_dwordx4 v235, s[96:99], s32 offen lds
    s_add_u32 m0, s34, 19968
    s_mov_b32 s32, 25088
    buffer_load_dwordx4 v235, s[96:99], s32 offen lds
    s_add_u32 m0, s34, 23552
    s_mov_b32 s32, 50176
    buffer_load_dwordx4 v235, s[96:99], s32 offen lds
    s_add_u32 m0, s34, 27136
    s_mov_b32 s32, 75264
    buffer_load_dwordx4 v235, s[96:99], s32 offen lds
    s_add_u32 m0, s34, 30720
    s_mov_b32 s32, 100352
    buffer_load_dwordx4 v235, s[96:99], s32 offen lds
    s_add_u32 m0, s34, 34304
    s_mov_b32 s32, 125440
    buffer_load_dwordx4 v235, s[96:99], s32 offen lds
    s_add_u32 m0, s34, 37888
    s_mov_b32 s32, 150528
    buffer_load_dwordx4 v235, s[96:99], s32 offen lds
    s_mov_b32 exec_hi, -1
    s_add_u32 m0, s34, 41472
    s_mov_b32 s32, 175616
    buffer_load_dwordx4 v236, s[96:99], s32 offen lds
    s_cmp_eq_u32 s59, 3
    s_cselect_b32 exec_hi, 0, -1
    s_add_u32 m0, s34, 123904
    s_mov_b32 s32, 200704
    buffer_load_dwordx4 v235, s[96:99], s32 offen lds
    s_add_u32 m0, s34, 127488
    s_mov_b32 s32, 225792
    buffer_load_dwordx4 v235, s[96:99], s32 offen lds
    s_add_u32 m0, s34, 131072
    s_mov_b32 s32, 250880
    buffer_load_dwordx4 v235, s[96:99], s32 offen lds
    s_add_u32 m0, s34, 134656
    s_mov_b32 s32, 275968
    buffer_load_dwordx4 v235, s[96:99], s32 offen lds
    s_add_u32 m0, s34, 138240
    s_mov_b32 s32, 301056
    buffer_load_dwordx4 v235, s[96:99], s32 offen lds
    s_add_u32 m0, s34, 141824
    s_mov_b32 s32, 326144
    buffer_load_dwordx4 v235, s[96:99], s32 offen lds
    s_add_u32 m0, s34, 145408
    s_mov_b32 s32, 351232
    buffer_load_dwordx4 v235, s[96:99], s32 offen lds
    s_mov_b32 exec_hi, -1
    s_add_u32 m0, s34, 148992
    s_mov_b32 s32, 376320
    buffer_load_dwordx4 v236, s[96:99], s32 offen lds
    global_load_dwordx2 v[30:31], v233, s[82:83] sc1
    ds_read_b64_tr_b16 v[32:33], v229 offset:0
    ds_read_b64_tr_b16 v[34:35], v229 offset:2048
    ds_read_b64_tr_b16 v[36:37], v230 offset:0
    ds_read_b64_tr_b16 v[38:39], v230 offset:2048
    ds_read_b64_tr_b16 v[40:41], v231 offset:0
    ds_read_b64_tr_b16 v[42:43], v231 offset:2048
    ds_read_b64_tr_b16 v[44:45], v232 offset:0
    ds_read_b64_tr_b16 v[46:47], v232 offset:2048
    ds_read_b64_tr_b16 v[48:49], v229 offset:3584
    ds_read_b64_tr_b16 v[50:51], v229 offset:5632
    s_waitcnt lgkmcnt(6)
    ds_read_b64_tr_b16 v[52:53], v230 offset:3584
    v_mfma_f32_16x16x32_bf16 v[56:59], v[32:35], v[76:79], 0
    ds_read_b64_tr_b16 v[54:55], v230 offset:5632
    ds_read_b64_tr_b16 v[32:33], v231 offset:3584
    v_mfma_f32_16x16x32_bf16 v[60:63], v[36:39], v[76:79], 0
    ds_read_b64_tr_b16 v[34:35], v231 offset:5632
    s_waitcnt lgkmcnt(6)
    ds_read_b64_tr_b16 v[36:37], v232 offset:3584
    v_mfma_f32_16x16x32_bf16 v[64:67], v[40:43], v[76:79], 0
    ds_read_b64_tr_b16 v[38:39], v232 offset:5632
    ds_read_b64_tr_b16 v[40:41], v229 offset:7168
    v_mfma_f32_16x16x32_bf16 v[68:71], v[44:47], v[76:79], 0
    ds_read_b64_tr_b16 v[42:43], v229 offset:9216
    s_waitcnt lgkmcnt(6)
    ds_read_b64_tr_b16 v[44:45], v230 offset:7168
    v_mfma_f32_16x16x32_bf16 v[56:59], v[48:51], v[80:83], v[56:59]
    ds_read_b64_tr_b16 v[46:47], v230 offset:9216
    ds_read_b64_tr_b16 v[48:49], v231 offset:7168
    v_mfma_f32_16x16x32_bf16 v[60:63], v[52:55], v[80:83], v[60:63]
    ds_read_b64_tr_b16 v[50:51], v231 offset:9216
    s_waitcnt lgkmcnt(6)
    ds_read_b64_tr_b16 v[52:53], v232 offset:7168
    v_mfma_f32_16x16x32_bf16 v[64:67], v[32:35], v[80:83], v[64:67]
    ds_read_b64_tr_b16 v[54:55], v232 offset:9216
    ds_read_b64_tr_b16 v[32:33], v229 offset:10752
    v_mfma_f32_16x16x32_bf16 v[68:71], v[36:39], v[80:83], v[68:71]
    ds_read_b64_tr_b16 v[34:35], v229 offset:12800
    s_waitcnt lgkmcnt(6)
    ds_read_b64_tr_b16 v[36:37], v230 offset:10752
    v_mfma_f32_16x16x32_bf16 v[56:59], v[40:43], v[84:87], v[56:59]
    ds_read_b64_tr_b16 v[38:39], v230 offset:12800
    ds_read_b64_tr_b16 v[40:41], v231 offset:10752
    v_mfma_f32_16x16x32_bf16 v[60:63], v[44:47], v[84:87], v[60:63]
    ds_read_b64_tr_b16 v[42:43], v231 offset:12800
    s_waitcnt lgkmcnt(6)
    ds_read_b64_tr_b16 v[44:45], v232 offset:10752
    v_mfma_f32_16x16x32_bf16 v[64:67], v[48:51], v[84:87], v[64:67]
    ds_read_b64_tr_b16 v[46:47], v232 offset:12800
    ds_read_b64_tr_b16 v[48:49], v229 offset:14336
    v_mfma_f32_16x16x32_bf16 v[68:71], v[52:55], v[84:87], v[68:71]
    ds_read_b64_tr_b16 v[50:51], v229 offset:16384
    s_waitcnt lgkmcnt(6)
    ds_read_b64_tr_b16 v[52:53], v230 offset:14336
    v_mfma_f32_16x16x32_bf16 v[56:59], v[32:35], v[88:91], v[56:59]
    ds_read_b64_tr_b16 v[54:55], v230 offset:16384
    ds_read_b64_tr_b16 v[32:33], v231 offset:14336
    v_mfma_f32_16x16x32_bf16 v[60:63], v[36:39], v[88:91], v[60:63]
    ds_read_b64_tr_b16 v[34:35], v231 offset:16384
    s_waitcnt lgkmcnt(6)
    ds_read_b64_tr_b16 v[36:37], v232 offset:14336
    v_mfma_f32_16x16x32_bf16 v[64:67], v[40:43], v[88:91], v[64:67]
    ds_read_b64_tr_b16 v[38:39], v232 offset:16384
    ds_read_b64_tr_b16 v[40:41], v229 offset:17920
    v_mfma_f32_16x16x32_bf16 v[68:71], v[44:47], v[88:91], v[68:71]
    ds_read_b64_tr_b16 v[42:43], v229 offset:19968
    s_waitcnt lgkmcnt(6)
    ds_read_b64_tr_b16 v[44:45], v230 offset:17920
    v_mfma_f32_16x16x32_bf16 v[56:59], v[48:51], v[92:95], v[56:59]
    ds_read_b64_tr_b16 v[46:47], v230 offset:19968
    ds_read_b64_tr_b16 v[48:49], v231 offset:17920
    v_mfma_f32_16x16x32_bf16 v[60:63], v[52:55], v[92:95], v[60:63]
    ds_read_b64_tr_b16 v[50:51], v231 offset:19968
    s_waitcnt lgkmcnt(6)
    ds_read_b64_tr_b16 v[52:53], v232 offset:17920
    v_mfma_f32_16x16x32_bf16 v[64:67], v[32:35], v[92:95], v[64:67]
    ds_read_b64_tr_b16 v[54:55], v232 offset:19968
    ds_read_b64_tr_b16 v[32:33], v229 offset:21504
    v_mfma_f32_16x16x32_bf16 v[68:71], v[36:39], v[92:95], v[68:71]
    ds_read_b64_tr_b16 v[34:35], v229 offset:23552
    s_waitcnt lgkmcnt(6)
    ds_read_b64_tr_b16 v[36:37], v230 offset:21504
    v_mfma_f32_16x16x32_bf16 v[56:59], v[40:43], v[96:99], v[56:59]
    ds_read_b64_tr_b16 v[38:39], v230 offset:23552
    ds_read_b64_tr_b16 v[40:41], v231 offset:21504
    v_mfma_f32_16x16x32_bf16 v[60:63], v[44:47], v[96:99], v[60:63]
    ds_read_b64_tr_b16 v[42:43], v231 offset:23552
    s_waitcnt lgkmcnt(6)
    ds_read_b64_tr_b16 v[44:45], v232 offset:21504
    v_mfma_f32_16x16x32_bf16 v[64:67], v[48:51], v[96:99], v[64:67]
    ds_read_b64_tr_b16 v[46:47], v232 offset:23552
    ds_read_b64_tr_b16 v[48:49], v229 offset:25088
    v_mfma_f32_16x16x32_bf16 v[68:71], v[52:55], v[96:99], v[68:71]
    ds_read_b64_tr_b16 v[50:51], v229 offset:27136
    s_waitcnt lgkmcnt(6)
    ds_read_b64_tr_b16 v[52:53], v230 offset:25088
    v_mfma_f32_16x16x32_bf16 v[56:59], v[32:35], v[100:103], v[56:59]
    ds_read_b64_tr_b16 v[54:55], v230 offset:27136
    ds_read_b64_tr_b16 v[32:33], v231 offset:25088
    v_mfma_f32_16x16x32_bf16 v[60:63], v[36:39], v[100:103], v[60:63]
    ds_read_b64_tr_b16 v[34:35], v231 offset:27136
    s_waitcnt lgkmcnt(6)
    ds_read_b64_tr_b16 v[36:37], v232 offset:25088
    v_mfma_f32_16x16x32_bf16 v[64:67], v[40:43], v[100:103], v[64:67]
    ds_read_b64_tr_b16 v[38:39], v232 offset:27136
    v_mfma_f32_16x16x32_bf16 v[68:71], v[44:47], v[100:103], v[68:71]
    s_waitcnt lgkmcnt(4)
    v_mfma_f32_16x16x32_bf16 v[56:59], v[48:51], v[104:107], v[56:59]
    v_mfma_f32_16x16x32_bf16 v[60:63], v[52:55], v[104:107], v[60:63]
    s_waitcnt lgkmcnt(0)
    v_mfma_f32_16x16x32_bf16 v[64:67], v[32:35], v[104:107], v[64:67]
    v_mfma_f32_16x16x32_bf16 v[68:71], v[36:39], v[104:107], v[68:71]
P3_loader_40_j:
    s_cmp_eq_u32 s55, 0
    s_mov_b32 s31, 46080
    s_cselect_b32 s31, 0xffff8000, s31

    v_add_u32 v229, s31, v229
    v_add_u32 v230, s31, v230
    v_add_u32 v231, s31, v231
    v_add_u32 v232, s31, v232
    s_lshl_b32 s33, s55, 15
    s_add_u32 s33, s33, 49152
    v_add_u32 v228, s33, v228
    s_add_u32 s33, s33, s34
    s_lshl_b32 s31, s55, 20
    s_add_u32 s31, s31, s52
    s_lshl_b32 s35, s101, 12

    s_mov_b32 s62, 0
gate_retry_43:
    s_waitcnt vmcnt(0)
    v_cmp_ne_u32 vcc, s3, v31
    s_add_u32 s62, s62, 1
    s_cmp_gt_u32 s62, 65536
    s_cbranch_scc1 gate_retry_43_done
    s_cbranch_vccz gate_retry_43_done
    global_load_dwordx2 v[30:31], v233, s[82:83] sc1
    s_branch gate_retry_43

gate_retry_43_done:
    s_barrier
    s_cmp_eq_u32 s55, 0
    s_cbranch_scc1 fprio_44
    s_setprio 1
fprio_44:
    s_mov_b32 s62, 0
oa_retry_45:
    s_add_u32 m0, s33, 0
    s_add_u32 s32, s31, 0
    buffer_load_dwordx4 v234, s[92:95], s32 offen sc1 lds
    s_add_u32 m0, s33, 4096
    s_add_u32 s32, s31, 131072
    buffer_load_dwordx4 v234, s[92:95], s32 offen sc1 lds
    s_add_u32 m0, s33, 8192
    s_add_u32 s32, s31, 262144
    buffer_load_dwordx4 v234, s[92:95], s32 offen sc1 lds
    s_add_u32 m0, s33, 12288
    s_add_u32 s32, s31, 393216
    buffer_load_dwordx4 v234, s[92:95], s32 offen sc1 lds
    s_add_u32 m0, s33, 16384
    s_add_u32 s32, s31, 524288
    buffer_load_dwordx4 v234, s[92:95], s32 offen sc1 lds
    s_add_u32 m0, s33, 20480
    s_add_u32 s32, s31, 655360
    buffer_load_dwordx4 v234, s[92:95], s32 offen sc1 lds
    s_add_u32 m0, s33, 24576
    s_add_u32 s32, s31, 786432
    buffer_load_dwordx4 v234, s[92:95], s32 offen sc1 lds
    s_add_u32 m0, s33, 28672
    s_add_u32 s32, s31, 917504
    buffer_load_dwordx4 v234, s[92:95], s32 offen sc1 lds
    s_mov_b64 s[36:37], 0
    v_cmp_gt_u32 s[38:39], 48, v1
    ds_read_b64_tr_b16 v[32:33], v229 offset:0
    ds_read_b64_tr_b16 v[34:35], v229 offset:2048
    ds_read_b64_tr_b16 v[36:37], v230 offset:0
    ds_read_b64_tr_b16 v[38:39], v230 offset:2048
    ds_read_b64_tr_b16 v[40:41], v231 offset:0
    ds_read_b64_tr_b16 v[42:43], v231 offset:2048
    ds_read_b64_tr_b16 v[44:45], v232 offset:0
    ds_read_b64_tr_b16 v[46:47], v232 offset:2048
    ds_read_b64_tr_b16 v[48:49], v229 offset:3584
    ds_read_b64_tr_b16 v[50:51], v229 offset:5632
    s_waitcnt vmcnt(7)
    ds_read_b128 v[76:79], v228 offset:0
    s_waitcnt vmcnt(6)
    ds_read_b128 v[80:83], v228 offset:4096
    s_waitcnt lgkmcnt(1)
    v_cmp_ne_u32 vcc, s3, v79
    v_cndmask_b32 v79, 0, v79, s[38:39]
    s_or_b64 s[36:37], s[36:37], vcc
    ds_read_b64_tr_b16 v[52:53], v230 offset:3584
    v_mfma_f32_16x16x32_bf16 v[140:143], v[32:35], v[76:79], 0
    ds_read_b64_tr_b16 v[54:55], v230 offset:5632
    ds_read_b64_tr_b16 v[32:33], v231 offset:3584
    v_mfma_f32_16x16x32_bf16 v[144:147], v[36:39], v[76:79], 0
    ds_read_b64_tr_b16 v[34:35], v231 offset:5632
    ds_read_b64_tr_b16 v[36:37], v232 offset:3584
    v_mfma_f32_16x16x32_bf16 v[148:151], v[40:43], v[76:79], 0
    ds_read_b64_tr_b16 v[38:39], v232 offset:5632
    ds_read_b64_tr_b16 v[40:41], v229 offset:7168
    v_mfma_f32_16x16x32_bf16 v[152:155], v[44:47], v[76:79], 0
    ds_read_b64_tr_b16 v[42:43], v229 offset:9216
    s_waitcnt vmcnt(5)
    ds_read_b128 v[84:87], v228 offset:8192
    s_waitcnt lgkmcnt(9)
    v_cmp_ne_u32 vcc, s3, v83
    v_cndmask_b32 v83, 0, v83, s[38:39]
    s_or_b64 s[36:37], s[36:37], vcc
    ds_read_b64_tr_b16 v[44:45], v230 offset:7168
    v_mfma_f32_16x16x32_bf16 v[140:143], v[48:51], v[80:83], v[140:143]
    ds_read_b64_tr_b16 v[46:47], v230 offset:9216
    s_waitcnt lgkmcnt(9)
    ds_read_b64_tr_b16 v[48:49], v231 offset:7168
    v_mfma_f32_16x16x32_bf16 v[144:147], v[52:55], v[80:83], v[144:147]
    ds_read_b64_tr_b16 v[50:51], v231 offset:9216
    s_waitcnt lgkmcnt(9)
    ds_read_b64_tr_b16 v[52:53], v232 offset:7168
    v_mfma_f32_16x16x32_bf16 v[148:151], v[32:35], v[80:83], v[148:151]
    ds_read_b64_tr_b16 v[54:55], v232 offset:9216
    s_waitcnt lgkmcnt(9)
    ds_read_b64_tr_b16 v[32:33], v229 offset:10752
    v_mfma_f32_16x16x32_bf16 v[152:155], v[36:39], v[80:83], v[152:155]
    ds_read_b64_tr_b16 v[34:35], v229 offset:12800
    s_waitcnt vmcnt(4)
    ds_read_b128 v[88:91], v228 offset:12288
    s_waitcnt lgkmcnt(9)
    v_cmp_ne_u32 vcc, s3, v87
    v_cndmask_b32 v87, 0, v87, s[38:39]
    s_or_b64 s[36:37], s[36:37], vcc
    ds_read_b64_tr_b16 v[36:37], v230 offset:10752
    v_mfma_f32_16x16x32_bf16 v[140:143], v[40:43], v[84:87], v[140:143]
    ds_read_b64_tr_b16 v[38:39], v230 offset:12800
    s_waitcnt lgkmcnt(9)
    ds_read_b64_tr_b16 v[40:41], v231 offset:10752
    v_mfma_f32_16x16x32_bf16 v[144:147], v[44:47], v[84:87], v[144:147]
    ds_read_b64_tr_b16 v[42:43], v231 offset:12800
    s_waitcnt lgkmcnt(9)
    ds_read_b64_tr_b16 v[44:45], v232 offset:10752
    v_mfma_f32_16x16x32_bf16 v[148:151], v[48:51], v[84:87], v[148:151]
    ds_read_b64_tr_b16 v[46:47], v232 offset:12800
    s_waitcnt lgkmcnt(9)
    ds_read_b64_tr_b16 v[48:49], v229 offset:14336
    v_mfma_f32_16x16x32_bf16 v[152:155], v[52:55], v[84:87], v[152:155]
    ds_read_b64_tr_b16 v[50:51], v229 offset:16384
    s_waitcnt vmcnt(3)
    ds_read_b128 v[92:95], v228 offset:16384
    s_waitcnt lgkmcnt(9)
    v_cmp_ne_u32 vcc, s3, v91
    v_cndmask_b32 v91, 0, v91, s[38:39]
    s_or_b64 s[36:37], s[36:37], vcc
    ds_read_b64_tr_b16 v[52:53], v230 offset:14336
    v_mfma_f32_16x16x32_bf16 v[140:143], v[32:35], v[88:91], v[140:143]
    ds_read_b64_tr_b16 v[54:55], v230 offset:16384
    s_waitcnt lgkmcnt(9)
    ds_read_b64_tr_b16 v[32:33], v231 offset:14336
    v_mfma_f32_16x16x32_bf16 v[144:147], v[36:39], v[88:91], v[144:147]
    ds_read_b64_tr_b16 v[34:35], v231 offset:16384
    s_waitcnt lgkmcnt(9)
    ds_read_b64_tr_b16 v[36:37], v232 offset:14336
    v_mfma_f32_16x16x32_bf16 v[148:151], v[40:43], v[88:91], v[148:151]
    ds_read_b64_tr_b16 v[38:39], v232 offset:16384
    s_waitcnt lgkmcnt(9)
    ds_read_b64_tr_b16 v[40:41], v229 offset:17920
    v_mfma_f32_16x16x32_bf16 v[152:155], v[44:47], v[88:91], v[152:155]
    ds_read_b64_tr_b16 v[42:43], v229 offset:19968
    s_waitcnt vmcnt(2)
    ds_read_b128 v[96:99], v228 offset:20480
    s_waitcnt lgkmcnt(9)
    v_cmp_ne_u32 vcc, s3, v95
    v_cndmask_b32 v95, 0, v95, s[38:39]
    s_or_b64 s[36:37], s[36:37], vcc
    ds_read_b64_tr_b16 v[44:45], v230 offset:17920
    v_mfma_f32_16x16x32_bf16 v[140:143], v[48:51], v[92:95], v[140:143]
    ds_read_b64_tr_b16 v[46:47], v230 offset:19968
    s_waitcnt lgkmcnt(9)
    ds_read_b64_tr_b16 v[48:49], v231 offset:17920
    v_mfma_f32_16x16x32_bf16 v[144:147], v[52:55], v[92:95], v[144:147]
    ds_read_b64_tr_b16 v[50:51], v231 offset:19968
    s_waitcnt lgkmcnt(9)
    ds_read_b64_tr_b16 v[52:53], v232 offset:17920
    v_mfma_f32_16x16x32_bf16 v[148:151], v[32:35], v[92:95], v[148:151]
    ds_read_b64_tr_b16 v[54:55], v232 offset:19968
    s_waitcnt lgkmcnt(9)
    ds_read_b64_tr_b16 v[32:33], v229 offset:21504
    v_mfma_f32_16x16x32_bf16 v[152:155], v[36:39], v[92:95], v[152:155]
    ds_read_b64_tr_b16 v[34:35], v229 offset:23552
    s_waitcnt vmcnt(1)
    ds_read_b128 v[100:103], v228 offset:24576
    s_waitcnt lgkmcnt(9)
    v_cmp_ne_u32 vcc, s3, v99
    v_cndmask_b32 v99, 0, v99, s[38:39]
    s_or_b64 s[36:37], s[36:37], vcc
    ds_read_b64_tr_b16 v[36:37], v230 offset:21504
    v_mfma_f32_16x16x32_bf16 v[140:143], v[40:43], v[96:99], v[140:143]
    ds_read_b64_tr_b16 v[38:39], v230 offset:23552
    s_waitcnt lgkmcnt(9)
    ds_read_b64_tr_b16 v[40:41], v231 offset:21504
    v_mfma_f32_16x16x32_bf16 v[144:147], v[44:47], v[96:99], v[144:147]
    ds_read_b64_tr_b16 v[42:43], v231 offset:23552
    s_waitcnt lgkmcnt(9)
    ds_read_b64_tr_b16 v[44:45], v232 offset:21504
    v_mfma_f32_16x16x32_bf16 v[148:151], v[48:51], v[96:99], v[148:151]
    ds_read_b64_tr_b16 v[46:47], v232 offset:23552
    s_waitcnt lgkmcnt(9)
    ds_read_b64_tr_b16 v[48:49], v229 offset:25088
    v_mfma_f32_16x16x32_bf16 v[152:155], v[52:55], v[96:99], v[152:155]
    ds_read_b64_tr_b16 v[50:51], v229 offset:27136
    s_waitcnt vmcnt(0)
    ds_read_b128 v[104:107], v228 offset:28672
    s_waitcnt lgkmcnt(9)
    v_cmp_ne_u32 vcc, s3, v103
    v_cndmask_b32 v103, 0, v103, s[38:39]
    s_or_b64 s[36:37], s[36:37], vcc
    ds_read_b64_tr_b16 v[52:53], v230 offset:25088
    v_mfma_f32_16x16x32_bf16 v[140:143], v[32:35], v[100:103], v[140:143]
    ds_read_b64_tr_b16 v[54:55], v230 offset:27136
    s_waitcnt lgkmcnt(9)
    ds_read_b64_tr_b16 v[32:33], v231 offset:25088
    v_mfma_f32_16x16x32_bf16 v[144:147], v[36:39], v[100:103], v[144:147]
    ds_read_b64_tr_b16 v[34:35], v231 offset:27136
    s_waitcnt lgkmcnt(9)
    ds_read_b64_tr_b16 v[36:37], v232 offset:25088
    v_mfma_f32_16x16x32_bf16 v[148:151], v[40:43], v[100:103], v[148:151]
    ds_read_b64_tr_b16 v[38:39], v232 offset:27136
    s_waitcnt lgkmcnt(9)
    v_mfma_f32_16x16x32_bf16 v[152:155], v[44:47], v[100:103], v[152:155]
    s_waitcnt lgkmcnt(6)
    v_cmp_ne_u32 vcc, s3, v107
    v_cndmask_b32 v107, 0, v107, s[38:39]
    s_or_b64 s[36:37], s[36:37], vcc
    s_nop 0
    v_mfma_f32_16x16x32_bf16 v[140:143], v[48:51], v[104:107], v[140:143]
    s_waitcnt lgkmcnt(4)
    v_mfma_f32_16x16x32_bf16 v[144:147], v[52:55], v[104:107], v[144:147]
    s_waitcnt lgkmcnt(2)
    v_mfma_f32_16x16x32_bf16 v[148:151], v[32:35], v[104:107], v[148:151]
    s_waitcnt lgkmcnt(0)
    v_mfma_f32_16x16x32_bf16 v[152:155], v[36:39], v[104:107], v[152:155]
    s_and_b32 vcc_hi, s37, 0xffff0000
    s_mov_b32 vcc_lo, 0
    s_add_u32 s62, s62, 1
    s_cmp_gt_u32 s62, 65536
    s_cbranch_scc1 oa_retry_45_done
    s_cbranch_vccz oa_retry_45_done
    s_sleep 2
    s_branch oa_retry_45

oa_retry_45_done:
    s_nop 6
    v_sub_f32 v140, v140, v56
    v_sub_f32 v141, v141, v57
    v_sub_f32 v142, v142, v58
    v_sub_f32 v143, v143, v59
    v_sub_f32 v144, v144, v60
    v_sub_f32 v145, v145, v61
    v_sub_f32 v146, v146, v62
    v_sub_f32 v147, v147, v63
    v_sub_f32 v148, v148, v64
    v_sub_f32 v149, v149, v65
    v_sub_f32 v150, v150, v66
    v_sub_f32 v151, v151, v67
    v_sub_f32 v152, v152, v68
    v_sub_f32 v153, v153, v69
    v_sub_f32 v154, v154, v70
    v_sub_f32 v155, v155, v71
    v_fma_f32 v140, v140, v30, v56
    v_fma_f32 v141, v141, v30, v57
    v_fma_f32 v142, v142, v30, v58
    v_fma_f32 v143, v143, v30, v59
    v_fma_f32 v144, v144, v30, v60
    v_fma_f32 v145, v145, v30, v61
    v_fma_f32 v146, v146, v30, v62
    v_fma_f32 v147, v147, v30, v63
    v_fma_f32 v148, v148, v30, v64
    v_fma_f32 v149, v149, v30, v65
    v_fma_f32 v150, v150, v30, v66
    v_fma_f32 v151, v151, v30, v67
    v_fma_f32 v152, v152, v30, v68
    v_fma_f32 v153, v153, v30, v69
    v_fma_f32 v154, v154, v30, v70
    v_fma_f32 v155, v155, v30, v71
    ds_write_b128 v241, v[140:143]
    v_xor_b32 v2, 64, v241
    ds_write_b128 v2, v[144:147]
    v_xor_b32 v2, 128, v241
    ds_write_b128 v2, v[148:151]
    v_xor_b32 v2, 192, v241
    ds_write_b128 v2, v[152:155]
    v_xor_b32 v3, 16, v239
    v_xor_b32 v4, 16, v240
    s_lshl_b32 s32, s101, 7
    s_waitcnt lgkmcnt(0)
    s_barrier
    ds_read_b128 v[108:111], v239
    ds_read_b128 v[112:115], v3
    ds_read_b128 v[116:119], v240
    ds_read_b128 v[120:123], v4
    s_waitcnt lgkmcnt(1)

    v_add_f32 v108, v108, v116
    v_add_f32 v109, v109, v117
    v_add_f32 v110, v110, v118
    v_add_f32 v111, v111, v119
    s_waitcnt lgkmcnt(0)
    v_add_f32 v112, v112, v120
    v_add_f32 v113, v113, v121
    v_add_f32 v114, v114, v122
    v_add_f32 v115, v115, v123
    v_cvt_pk_bf16_f32 v108, v108, v109
    v_cvt_pk_bf16_f32 v109, v110, v111
    v_cvt_pk_bf16_f32 v110, v112, v113
    v_cvt_pk_bf16_f32 v111, v114, v115
    buffer_store_dwordx4 v[108:111], v238, s[88:91], s32 offen
K_FIN:
K_END:
    s_endpgm
K_CODE_END:
.section .rodata,"a"
.p2align 6
.amdhsa_kernel gated_mix__sliding_block__sliding_local_dilated__prompt_kernel
  .amdhsa_next_free_vgpr 256
  .amdhsa_next_free_sgpr 102
  .amdhsa_accum_offset 256
  .amdhsa_group_segment_fixed_size 0
  .amdhsa_kernarg_size 80
  .amdhsa_user_sgpr_count 2
  .amdhsa_user_sgpr_kernarg_segment_ptr 1
  .amdhsa_system_sgpr_workgroup_id_x 1
  .amdhsa_float_denorm_mode_32 3
.end_amdhsa_kernel
```
